```python
import torch

def _softmax(x, axis=-1):
    return torch.softmax(x, dim=axis)
def _gelu(x):
    return torch.nn.functional.gelu(x, approximate="tanh")
def _silu(x):
    return torch.nn.functional.silu(x)
def _sigmoid(x):
    return torch.sigmoid(x)
def _layernorm(x, axis=-1, eps=1e-5):
    m = x.mean(dim=axis, keepdim=True)
    v = x.var(dim=axis, keepdim=True, unbiased=False)
    return (x - m) / torch.sqrt(v + eps)
def _scatter_add(tgt, idx, src, axis=0):
    return tgt.clone().index_add_(axis, idx, src)
def _segment_sum(src, seg, n):
    out = torch.zeros((n,) + src.shape[1:], dtype=src.dtype)
    return out.index_add_(0, seg, src)
def _pad(x, pw):
    flat = tuple(v for pair in reversed(pw) for v in pair)
    return torch.nn.functional.pad(x, flat)

kernel_name = 'sequential_preLN__spectral_fnet__moe_arch_mod__prompt'

def setup_inputs():

    _w = (lambda a: (lambda t: t.to(torch.bfloat16) if t.is_floating_point() else t)(torch.as_tensor(a)))
    def _A_setup():
        B, S, D = 1, 2048, 640
        ns = torch.arange(S)[:, None] * torch.arange(S)[None, :]
        nd = torch.arange(D)[:, None] * torch.arange(D)[None, :]
        Ws_re = torch.cos(-2.0 * torch.pi * ns / S).to(float)
        Ws_im = torch.sin(-2.0 * torch.pi * ns / S).to(float)
        Wd_re = torch.cos(-2.0 * torch.pi * nd / D).to(float)
        Wd_im = torch.sin(-2.0 * torch.pi * nd / D).to(float)
        return {
            "x": _w((lambda *s: torch.randn(*s, dtype=torch.bfloat16) * 0.1)(B, S, D)),
            "dft_seq_re": _w(Ws_re),
            "dft_seq_im": _w(Ws_im),
            "dft_hid_re": _w(Wd_re),
            "dft_hid_im": _w(Wd_im),
        }
    _A_in = _A_setup()

    def _B_setup():
        B, S, D, F, C = 1, 2048, 640, 1728, 8
        return {
            "x": _w((lambda *s: torch.randn(*s, dtype=torch.bfloat16) * 0.1)(B, S, D)),
            "w_r": _w((lambda *s: torch.randn(*s, dtype=torch.bfloat16) * 1.6)(D)),
            "w_gate": _w((lambda *s: torch.randn(*s, dtype=torch.bfloat16) * 0.8)(D, F)),
            "w_up": _w((lambda *s: torch.randn(*s, dtype=torch.bfloat16) * 0.8)(D, F)),
            "w_down": _w((lambda *s: torch.randn(*s, dtype=torch.bfloat16) * 0.8)(F, D)),
        }
    _B_in = _B_setup()

    return {
        "A_x": _A_in["x"],
        "A_dft_seq_re": _A_in["dft_seq_re"],
        "A_dft_seq_im": _A_in["dft_seq_im"],
        "A_dft_hid_re": _A_in["dft_hid_re"],
        "A_dft_hid_im": _A_in["dft_hid_im"],
        "B_x": _B_in["x"],
        "B_w_r": _B_in["w_r"],
        "B_w_gate": _B_in["w_gate"],
        "B_w_up": _B_in["w_up"],
        "B_w_down": _B_in["w_down"],
    }

def reference(A_x, A_dft_seq_re, A_dft_seq_im, A_dft_hid_re, A_dft_hid_im, B_x, B_w_r, B_w_gate, B_w_up, B_w_down):
    def _A_ref(x, dft_seq_re, dft_seq_im, dft_hid_re, dft_hid_im):
        a = torch.einsum("bsd,ed->bse", x, dft_hid_re)
        b = torch.einsum("bsd,ed->bse", x, dft_hid_im)
        y = torch.einsum("ts,bse->bte", dft_seq_re, a) - torch.einsum("ts,bse->bte", dft_seq_im, b)
        return y

    def _B_ref(x, w_r, w_gate, w_up, w_down):
        B, S, D = x.shape
        C = 8
        r = x @ w_r
        idx = torch.argsort(-r, axis=-1)[:, :C]
        idx_e = (lambda x, n, axis: torch.repeat_interleave(x, n, dim=axis))(idx.reshape(B, C, 1), D, axis=2)
        x_sel = (lambda x, i, axis: torch.take_along_dim(x, i, dim=axis))(x, idx_e, axis=1)
        g = _silu(x_sel @ w_gate)
        u = x_sel @ w_up
        y = (g * u) @ w_down
        r_sel = _sigmoid((lambda x, i, axis: torch.take_along_dim(x, i, dim=axis))(r, idx, axis=1))
        y = y * r_sel.reshape(B, C, 1)
        b_off = (torch.arange(B) * S).reshape(B, 1)
        flat_idx = (idx + b_off).reshape(B * C)
        zero = (x * 0.0).reshape(B * S, D)
        upd = _scatter_add(zero, flat_idx, y.reshape(B * C, D), axis=0)
        return x + upd.reshape(B, S, D)

    x = A_x
    h = x + _A_ref(_layernorm(x, axis=-1), A_dft_seq_re, A_dft_seq_im, A_dft_hid_re, A_dft_hid_im)
    h2 = h + _B_ref(_layernorm(h, axis=-1), B_w_r, B_w_gate, B_w_up, B_w_down)
    return h2
```

```asm
; @launch grid=(256,1,1) block=(512,1,1) lds=155648
.amdgcn_target "amdgcn-amd-amdhsa--gfx950"
.text
.p2align 12
.fill 0x340, 4, 0xbf810000
.globl sequential_preLN__spectral_fnet__moe_arch_mod__prompt_kernel
.p2align 8
.type sequential_preLN__spectral_fnet__moe_arch_mod__prompt_kernel,@function
sequential_preLN__spectral_fnet__moe_arch_mod__prompt_kernel:
L_start:
    s_load_dwordx2 s[4:5], s[0:1], 0
    s_mov_b32 s10, 4194304
    s_mov_b32 s11, 0x20000
    v_lshrrev_b32 v3, 6, v0
    s_cmp_ge_u32 s2, 256
    s_cbranch_scc1 L_end
    v_readfirstlane_b32 s34, v3
    s_bfe_u32 s33, s2, 0x30003
    v_and_b32 v4, 63, v0
    v_and_b32 v1, 15, v0
    v_bfe_u32 v2, v0, 4, 2
    s_and_b32 s37, s2, 7
    s_lshr_b32 s43, s2, 7
    s_lshl1_add_u32 s32, s37, s43
    s_sub_u32 s43, 32, s32
    s_cmp_eq_u32 s32, 0
    s_cselect_b32 s43, 16, s43
    s_bitcmp1_b32 s2, 6
    s_cselect_b32 s32, s43, s32
    s_mul_i32 s44, s33, 5
    s_lshr_b32 s44, s44, 2
    s_and_b32 s46, s34, 3
    s_mov_b32 s45, 0x3acccccd
    v_lshlrev_b32 v8, 4, v4
    s_cmp_ge_u32 s34, 4
    s_cbranch_scc1 L_W
    s_cmp_ge_u32 s34, 3
    s_cbranch_scc1 L_Mx
    s_lshr_b32 s43, s2, 5
    s_cmp_lg_u32 s43, 0
    s_cbranch_scc1 L_Mx
    s_getpc_b64 s[42:43]
L_pc:
    v_lshlrev_b32 v10, 7, v0
    v_add_u32 v10, 896, v10
    v_min_u32 v10, L_last-L_pc, v10
    v_mov_b32 v11, s43
    v_add_co_u32 v10, vcc, s42, v10
    s_nop 1
    v_addc_co_u32 v11, vcc, 0, v11, vcc
    global_load_dword v15, v[10:11], off
L_Mx:
    v_lshrrev_b32 v9, 3, v4
    s_lshl_b32 s47, s46, 4
    v_add_u32 v5, s47, v9
    v_mul_u32_u24 v5, 40960, v5
    v_lshrrev_b32 v7, 2, v9
    v_and_or_b32 v9, v9, 6, v7
    v_xor_b32 v9, v9, v4
    v_and_b32 v9, 7, v9
    v_lshl_add_u32 v5, v9, 4, v5
    v_xor_b32 v7, 16, v5
    v_add_u32 v7, 327680, v7
    s_mul_i32 s50, s32, 1280
    s_add_u32 s47, s50, 1280
    s_lshr_b32 s52, s34, 2
    s_mul_i32 s52, s52, 5
    s_add_u32 s48, s44, s52
    s_cmp_ge_u32 s48, 10
    s_cselect_b32 s49, 10, 0
    s_sub_u32 s48, s48, s49
    s_lshl_b32 s48, s48, 7
    s_add_u32 s48, s48, s50
    s_mul_i32 s49, s46, 20480
    s_add_u32 s49, s49, 32768
    s_lshl_b32 s52, s52, 11
    s_add_u32 m0, s49, s52
    s_mov_b32 s6, 2621440
    s_mov_b32 s7, 0x20000
    s_mov_b32 s52, 5
    s_waitcnt lgkmcnt(0)
    s_cmp_lt_u32 s34, 4
    s_cbranch_scc1 L_xl
    s_load_dword s3, s[8:9], 0
    s_barrier
    s_branch L_H1
L_xl:
    buffer_load_dwordx4 v5, s[4:7], s48 offen lds
    s_add_u32 m0, m0, 1024
    s_add_u32 s51, s48, 128
    buffer_load_dwordx4 v7, s[4:7], s48 offen lds
    s_add_u32 m0, m0, 1024
    s_cmp_eq_u32 s51, s47
    s_cselect_b32 s48, s50, s51
    s_sub_u32 s52, s52, 1
    s_cmp_lg_u32 s52, 0
    s_cbranch_scc1 L_xl
    s_cmp_ge_u32 s34, 4
    s_cbranch_scc1 L_H2
    s_load_dwordx2 s[8:9], s[0:1], 96
    s_load_dwordx16 s[16:31], s[0:1], 40
    s_barrier
    s_branch L_M
L_W:
    s_load_dwordx2 s[8:9], s[0:1], 96
    s_load_dwordx16 s[16:31], s[0:1], 40
    s_cmp_eq_u32 s33, 0
    s_cselect_b32 s53, 8, s33
    s_lshl_b32 s54, s44, 6
    s_lshl_b32 s55, s46, 6
    s_add_u32 s53, s53, s55
    v_and_b32 v78, 7, v1
    v_lshl_add_u32 v78, v78, 3, s53
    v_lshrrev_b32 v80, 3, v1
    v_lshl_add_u32 v79, v2, 1, s54
    v_cvt_f32_u32 v80, v80
    v_mul_u32_u24 v79, v78, v79
    v_mul_f32 v80, 0xbe800000, v80
    v_cvt_f32_u32 v78, v78
    v_cvt_f32_u32 v79, v79
    v_mul_f32 v78, s45, v78
    v_fma_f32 v79, v79, s45, v80
    v_mul_f32 v76, 0x41000000, v78
    v_fract_f32 v32, v79
    v_add_f32 v34, v32, v78
    v_add_f32 v36, v32, v76
    v_add_f32 v38, v34, v76
    v_cos_f32 v76, v76
    v_sin_f32 v33, -v32
    v_cos_f32 v32, v32
    v_sin_f32 v35, -v34
    v_cos_f32 v34, v34
    v_sin_f32 v37, -v36
    v_cos_f32 v36, v36
    v_sin_f32 v39, -v38
    v_cos_f32 v38, v38
    v_add_f32 v76, v76, v76
    s_mul_i32 s55, s46, 5120
    v_add_u32 v81, s55, v8
    v_mov_b32 v77, v76
    v_cvt_pk_bf16_f32 v84, v32, v33
    v_cvt_pk_bf16_f32 v85, v34, v35
    v_cvt_pk_bf16_f32 v86, v36, v37
    v_cvt_pk_bf16_f32 v87, v38, v39
    ds_write_b128 v81, v[84:87] offset:12288
    v_pk_fma_f32 v[40:41], v[76:77], v[36:37], v[32:33] neg_lo:[0,0,1] neg_hi:[0,0,1]
    v_pk_fma_f32 v[42:43], v[76:77], v[38:39], v[34:35] neg_lo:[0,0,1] neg_hi:[0,0,1]
    v_pk_fma_f32 v[44:45], v[76:77], v[40:41], v[36:37] neg_lo:[0,0,1] neg_hi:[0,0,1]
    v_pk_fma_f32 v[46:47], v[76:77], v[42:43], v[38:39] neg_lo:[0,0,1] neg_hi:[0,0,1]
    v_cvt_pk_bf16_f32 v88, v40, v41
    v_cvt_pk_bf16_f32 v89, v42, v43
    v_cvt_pk_bf16_f32 v90, v44, v45
    v_cvt_pk_bf16_f32 v91, v46, v47
    ds_write_b128 v81, v[88:91] offset:13312
    v_pk_fma_f32 v[48:49], v[76:77], v[44:45], v[40:41] neg_lo:[0,0,1] neg_hi:[0,0,1]
    v_pk_fma_f32 v[50:51], v[76:77], v[46:47], v[42:43] neg_lo:[0,0,1] neg_hi:[0,0,1]
    v_pk_fma_f32 v[52:53], v[76:77], v[48:49], v[44:45] neg_lo:[0,0,1] neg_hi:[0,0,1]
    v_pk_fma_f32 v[54:55], v[76:77], v[50:51], v[46:47] neg_lo:[0,0,1] neg_hi:[0,0,1]
    v_cvt_pk_bf16_f32 v84, v48, v49
    v_cvt_pk_bf16_f32 v85, v50, v51
    v_cvt_pk_bf16_f32 v86, v52, v53
    v_cvt_pk_bf16_f32 v87, v54, v55
    ds_write_b128 v81, v[84:87] offset:14336
    v_pk_fma_f32 v[56:57], v[76:77], v[52:53], v[48:49] neg_lo:[0,0,1] neg_hi:[0,0,1]
    v_pk_fma_f32 v[58:59], v[76:77], v[54:55], v[50:51] neg_lo:[0,0,1] neg_hi:[0,0,1]
    v_pk_fma_f32 v[60:61], v[76:77], v[56:57], v[52:53] neg_lo:[0,0,1] neg_hi:[0,0,1]
    v_pk_fma_f32 v[62:63], v[76:77], v[58:59], v[54:55] neg_lo:[0,0,1] neg_hi:[0,0,1]
    v_cvt_pk_bf16_f32 v88, v56, v57
    v_cvt_pk_bf16_f32 v89, v58, v59
    v_cvt_pk_bf16_f32 v90, v60, v61
    v_cvt_pk_bf16_f32 v91, v62, v63
    ds_write_b128 v81, v[88:91] offset:15360
    v_pk_fma_f32 v[64:65], v[76:77], v[60:61], v[56:57] neg_lo:[0,0,1] neg_hi:[0,0,1]
    v_pk_fma_f32 v[66:67], v[76:77], v[62:63], v[58:59] neg_lo:[0,0,1] neg_hi:[0,0,1]
    v_pk_fma_f32 v[68:69], v[76:77], v[64:65], v[60:61] neg_lo:[0,0,1] neg_hi:[0,0,1]
    v_pk_fma_f32 v[70:71], v[76:77], v[66:67], v[62:63] neg_lo:[0,0,1] neg_hi:[0,0,1]
    v_cvt_pk_bf16_f32 v84, v64, v65
    v_cvt_pk_bf16_f32 v85, v66, v67
    v_cvt_pk_bf16_f32 v86, v68, v69
    v_cvt_pk_bf16_f32 v87, v70, v71
    ds_write_b128 v81, v[84:87] offset:16384
    s_branch L_Mx
L_H1:
    s_mov_b64 s[12:13], s[26:27]
    s_mov_b64 s[16:17], s[18:19]
    s_mov_b64 s[28:29], s[24:25]
    s_mov_b64 s[24:25], s[22:23]
    s_mov_b32 s14, 2621440
    s_mov_b32 s15, 0x20000
    s_mov_b32 s18, 1280
    s_mov_b32 s19, 0x20000
    s_mov_b32 s22, 2211840
    s_mov_b32 s23, 0x20000
    s_mov_b32 s26, 2211840
    s_mov_b32 s27, 0x20000
    s_mov_b32 s30, 2211840
    s_mov_b32 s31, 0x20000
    v_lshlrev_b32 v6, 2, v4
    v_mov_b32 v13, 0
    s_and_b32 s43, s33, 3
    s_lshr_b32 s35, s2, 6
    s_lshl3_add_u32 s35, s35, s37
    s_lshl2_add_u32 s35, s35, s43
    s_cmp_eq_u32 s32, 0
    s_cselect_b32 s39, 32, 64
    s_lshl_b32 s38, s39, 3
    s_mul_i32 s38, s38, s43
    s_add_u32 s38, s38, s32
    v_mov_b32 v152, -1
    v_mov_b32 v153, -1
    v_mov_b32 v154, -1
    v_mov_b32 v155, -1
    v_lshrrev_b32 v150, 1, v4
    v_and_b32 v9, 2, v150
    v_bfe_u32 v10, v150, 3, 1
    v_and_b32 v150, 21, v150
    v_lshl_or_b32 v150, v9, 2, v150
    v_lshl_or_b32 v150, v10, 1, v150
    v_mul_u32_u24 v150, 3456, v150
    v_and_b32 v9, 1, v4
    v_lshl_add_u32 v150, v9, 4, v150
    v_mul_u32_u24 v151, 1280, v4
    s_cmp_ge_u32 s33, 4
    s_cbranch_scc1 L_hs1
    s_add_u32 s56, s46, 0
    s_mul_i32 s56, s56, s39
    s_add_u32 s56, s56, s38
    s_sub_u32 s57, 2048, s56
    s_cmp_eq_u32 s56, 0
    s_cselect_b32 s57, 1024, s57
    s_mul_i32 s56, s56, 1280
    s_mul_i32 s57, s57, 1280
    s_add_u32 s58, s46, 4
    s_mul_i32 s58, s58, s39
    s_add_u32 s58, s58, s38
    s_sub_u32 s59, 2048, s58
    s_cmp_eq_u32 s58, 0
    s_cselect_b32 s59, 1024, s59
    s_mul_i32 s58, s58, 1280
    s_mul_i32 s59, s59, 1280
    v_mov_b32 v10, s56
    v_mov_b32 v9, s57
    v_mov_b32 v11, s58
    v_mov_b32 v12, s59
    v_mov_b32_dpp v10, v9 quad_perm:[0,1,2,3] row_mask:0x2 bank_mask:0xf
    s_movk_i32 s62, 1024
    s_nop 0
    v_mov_b32_dpp v10, v11 quad_perm:[0,1,2,3] row_mask:0x4 bank_mask:0xf
    s_nop 1
    v_mov_b32_dpp v10, v12 quad_perm:[0,1,2,3] row_mask:0x8 bank_mask:0xf
    v_lshl_add_u32 v107, v1, 4, v10
    s_mul_i32 s53, s46, 1284
    s_mul_i32 s54, s46, 320
    s_mov_b32 s55, m0
    s_add_u32 m0, s54, 139520
    s_mov_b64 exec, 0xfffff
    buffer_load_dwordx4 v8, s[16:19], s54 offen lds
    s_mov_b64 exec, -1
    s_mov_b32 m0, s55
    s_branch L_xl
L_hs1:
    v_mov_b32 v107, 0
    s_and_b32 s63, s33, 3
    s_lshl2_add_u32 s63, s63, s46
    s_and_b32 s56, s33, 3
    s_mul_i32 s56, s56, 5
    s_add_u32 s57, s56, 4
    s_add_u32 s56, s56, s46
    s_lshl_b32 s43, s35, 5
    s_mul_i32 s58, s56, 110592
    s_add_u32 s58, s58, s43
    s_mul_i32 s59, s57, 110592
    s_add_u32 s59, s59, s43
    s_and_b32 s43, s56, 28
    s_add_u32 s56, s56, s43
    s_lshl_b32 s56, s56, 10
    s_and_b32 s43, s57, 28
    s_add_u32 s57, s57, s43
    s_lshl_b32 s57, s57, 10
    s_lshl_b32 s43, s46, 4
    s_bfm_b64 s[60:61], 16, s43
    s_and_b32 s63, s63, 7
    s_mul_i32 s65, s63, 69120
    s_sub_u32 s43, s35, 108
    s_lshr_b32 s43, s43, 1
    s_lshl_b32 s43, s43, 7
    s_add_u32 s65, s65, s43
    s_lshl2_add_u32 s63, s35, s46
    s_lshl_b32 s63, s63, 6
    s_add_u32 s63, s63, 98304
    s_branch L_xl
L_H2:
    s_barrier
    s_cmp_ge_u32 s33, 4
    s_cbranch_scc1 L_hc1
    s_add_u32 m0, s53, 118784
    s_nop 0
    buffer_load_dwordx4 v8, s[4:7], s56 offen lds
    s_add_u32 m0, s53, 129056
    s_nop 0
    buffer_load_dwordx4 v8, s[4:7], s57 offen lds
    s_add_u32 m0, s53, 123920
    s_nop 0
    buffer_load_dwordx4 v8, s[4:7], s58 offen lds
    s_add_u32 m0, s53, 134192
    s_nop 0
    buffer_load_dwordx4 v8, s[4:7], s59 offen lds
    s_mov_b64 exec, 0xffff
    s_add_u32 m0, s53, 118784
    s_nop 0
    buffer_load_dwordx4 v8, s[4:7], s56 offen offset:1024 lds
    s_add_u32 m0, s53, 129056
    s_nop 0
    buffer_load_dwordx4 v8, s[4:7], s57 offen offset:1024 lds
    s_add_u32 m0, s53, 123920
    s_nop 0
    buffer_load_dwordx4 v8, s[4:7], s58 offen offset:1024 lds
    s_add_u32 m0, s53, 134192
    s_nop 0
    buffer_load_dwordx4 v8, s[4:7], s59 offen offset:1024 lds
    s_mov_b64 exec, -1
    s_waitcnt vmcnt(8)
    s_barrier
    buffer_store_dwordx4 v[152:155], v8, s[12:15], s56 offen sc1
    buffer_store_dwordx4 v[152:155], v8, s[12:15], s57 offen sc1
    buffer_store_dwordx4 v[152:155], v8, s[12:15], s58 offen sc1
    buffer_store_dwordx4 v[152:155], v8, s[12:15], s59 offen sc1
    buffer_store_dwordx4 v[152:155], v107, s[12:15], s62 offen sc1
    s_branch L_hs4
L_hc1:
    s_cmp_ge_u32 s35, 108
    s_cbranch_scc1 L_hs2
    s_mov_b64 exec, 15
    buffer_store_dwordx4 v[152:155], v8, s[8:11], s63 offen sc1
    s_mov_b64 exec, -1
    s_add_u32 m0, s56, 114688
    s_nop 0
    buffer_load_dwordx4 v150, s[20:23], s58 offen lds
    s_add_u32 m0, s56, 118784
    s_nop 0
    buffer_load_dwordx4 v150, s[24:27], s58 offen lds
    s_add_u32 m0, s57, 114688
    s_mov_b64 exec, s[60:61]
    buffer_load_dwordx4 v150, s[20:23], s59 offen lds
    s_add_u32 m0, s57, 118784
    s_nop 0
    buffer_load_dwordx4 v150, s[24:27], s59 offen lds
    s_lshr_b32 s65, s2, 6
    s_and_b32 s43, s33, 3
    s_lshl2_add_u32 s65, s65, s43
    s_lshr_b32 s43, s46, 1
    s_lshl1_add_u32 s65, s65, s43
    s_mul_i32 s65, s65, 46080
    s_and_b32 s43, s46, 1
    s_lshl1_add_u32 s43, s37, s43
    s_lshl_b32 s43, s43, 7
    s_add_u32 s65, s65, s43
    s_add_u32 s65, s65, 1105152
    s_cmp_lt_u32 s37, 3
    s_cselect_b32 s65, 16777216, s65
    s_mov_b32 s64, 0xf
    s_waitcnt vmcnt(5)
    s_branch L_hs3
L_hs2:
    s_mov_b32 exec_hi, 0x3fffff
    buffer_load_dword v253, v151, s[28:31], s65 offen
    s_add_u32 s65, s65, 552960
    s_mov_b32 s64, 0x3fffff
    s_waitcnt vmcnt(1)
L_hs3:
    s_barrier
L_hs4:
    s_mov_b64 exec, -1
    s_waitcnt lgkmcnt(0)
    s_mul_i32 s3, s3, 0x9e3779b1
    s_add_u32 s3, s3, 0x7f4a7c15
    v_mov_b32 v14, s3
    s_and_b32 s43, s3, 3
    s_mul_i32 s43, s43, 0x01010101
    s_and_b32 s66, s3, 0xfcfcfcfc
    s_or_b32 s43, s43, s66
    v_lshlrev_b32 v48, 1, v1
    v_bfe_u32 v48, s43, v48, 2
    v_mul_u32_u24 v48, 0x8001, v48
    v_and_b32 v48, 0x10001, v48
    v_lshlrev_b32 v49, 2, v1
    ds_write_b32 v49, v48 offset:64
    ds_write2_b32 v13, v13, v14 offset0:0 offset1:1
    ds_write_b32 v6, v152 offset:192
    s_cmp_ge_u32 s33, 4
    s_cbranch_scc1 L_hf
    s_waitcnt vmcnt(5) lgkmcnt(0)
    s_barrier
    v_and_b32 v10, 7, v1
    v_mul_u32_u24 v10, s39, v10
    v_add_u32 v10, s38, v10
    v_sub_u32 v11, 2048, v10
    v_mov_b32 v12, 1024
    v_cmp_eq_u32 vcc, 0, v10
    s_nop 1
    v_cndmask_b32 v11, v11, v12, vcc
    v_cmp_lt_u32 vcc, 7, v1
    s_nop 1
    v_cndmask_b32 v10, v10, v11, vcc
    v_and_b32 v11, 63, v10
    v_bfrev_b32 v12, 1
    v_cmp_gt_u32 vcc, 32, v11
    s_nop 1
    v_cndmask_b32 v12, 0, v12, vcc
    v_lshrrev_b32 v9, 1, v11
    s_lshl_b32 s49, s46, 3
    v_add_u32 v11, s49, v2
    v_mul_u32_u24 v11, v11, v10
    v_cvt_f32_u32 v11, v11
    v_mul_f32 v11, 0x3a000000, v11
    v_cos_f32 v36, v11
    v_sin_f32 v37, v11
    s_add_u32 s49, s49, 4
    v_cvt_pk_f16_f32 v32, v36, v37
    v_cvt_pk_f16_f32 v33, -v37, v36
    v_xor_b32 v32, v12, v32
    v_xor_b32 v33, v12, v33
    v_add_u32 v11, s49, v2
    v_mul_u32_u24 v11, v11, v10
    v_cvt_f32_u32 v11, v11
    v_mul_f32 v11, 0x3a000000, v11
    v_cos_f32 v36, v11
    v_sin_f32 v37, v11
    s_add_u32 s49, s49, 4
    v_cvt_pk_f16_f32 v34, v36, v37
    v_cvt_pk_f16_f32 v35, -v37, v36
    v_xor_b32 v34, v12, v34
    v_xor_b32 v35, v12, v35
    s_cmp_lg_u32 s32, 0
    s_cbranch_scc1 L_nofix
    v_and_b32 v32, 0xffff, v32
    v_lshlrev_b32 v32, v9, v32
    v_and_b32 v33, 0xffff, v33
    v_lshlrev_b32 v33, v9, v33
    v_and_b32 v34, 0xffff, v34
    v_lshlrev_b32 v34, v9, v34
    v_and_b32 v35, 0xffff, v35
    v_lshlrev_b32 v35, v9, v35
L_nofix:
    s_lshl_b32 s49, s46, 10
    s_add_u32 s49, s49, 114688
    v_add_u32 v11, s49, v8
    ds_write_b128 v11, v[32:35]
    s_branch L_prep
L_hf:
    s_waitcnt lgkmcnt(0)
    s_barrier
    s_waitcnt vmcnt(4)
    s_barrier
    s_mov_b32 exec_hi, s64
    buffer_load_dword v253, v151, s[28:31], s65 offen
    s_mov_b64 exec, -1
    s_branch L_noflag
L_tprep:
    s_movk_i32 s49, 528
    v_cmp_eq_u32 s[52:53], s49, v9
    v_add_u32 v228, 320, v225
    s_nop 0
    v_cndmask_b32 v228, v228, v11, s[52:53]
    ds_read_u16_d16_hi v112, v224 offset:0
    ds_read_u16_d16_hi v113, v224 offset:64
    ds_read_u16_d16_hi v116, v224 offset:16
    ds_read_u16_d16_hi v117, v224 offset:80
    ds_read_u16_d16_hi v120, v224 offset:32
    ds_read_u16_d16_hi v121, v224 offset:96
    ds_read_u16_d16_hi v124, v224 offset:48
    ds_read_u16_d16_hi v125, v224 offset:112
    ds_read_u16_d16_hi v128, v225 offset:432
    ds_read_u16_d16_hi v129, v225 offset:368
    ds_read_u16_d16_hi v130, v225 offset:416
    ds_read_u16_d16_hi v131, v225 offset:352
    ds_read_u16_d16_hi v132, v225 offset:400
    ds_read_u16_d16_hi v133, v225 offset:336
    ds_read_u16_d16_hi v134, v225 offset:384
    ds_read_u16_d16_hi v135, v228
    v_mov_b32 v144, v12
    v_mov_b32 v152, v12
    v_mov_b32 v114, 0
    v_mov_b32 v115, 0
    v_mov_b32 v145, v12
    v_mov_b32 v153, v12
    v_mov_b32 v118, 0
    v_mov_b32 v119, 0
    v_mov_b32 v146, v12
    v_mov_b32 v154, v12
    v_mov_b32 v122, 0
    v_mov_b32 v123, 0
    v_mov_b32 v147, v12
    v_mov_b32 v155, v12
    v_mov_b32 v126, 0
    v_mov_b32 v127, 0
    s_waitcnt lgkmcnt(0)
    v_mov_b32 v136, v135
    v_pk_add_f32 v[128:129], v[128:129], v[112:113] neg_lo:[0,1] neg_hi:[0,1]
    v_pk_add_f32 v[130:131], v[130:131], v[116:117] neg_lo:[0,1] neg_hi:[0,1]
    v_pk_add_f32 v[132:133], v[132:133], v[120:121] neg_lo:[0,1] neg_hi:[0,1]
    v_pk_add_f32 v[134:135], v[134:135], v[124:125] neg_lo:[0,1] neg_hi:[0,1]
    s_barrier
    buffer_load_dwordx4 v[16:19], v5, s[8:11], s58 offen sc1
    buffer_load_dwordx4 v[20:23], v5, s[8:11], s59 offen sc1
    buffer_load_dwordx4 v[24:27], v5, s[8:11], s60 offen sc1
    buffer_load_dwordx4 v[28:31], v5, s[8:11], s61 offen sc1
    buffer_load_dwordx4 v[32:35], v5, s[8:11], s62 offen sc1
    buffer_load_dwordx4 v[36:39], v5, s[8:11], s63 offen sc1
    buffer_load_dwordx4 v[40:43], v5, s[8:11], s64 offen sc1
    buffer_load_dwordx4 v[44:47], v5, s[8:11], s65 offen sc1
    s_mov_b32 s50, 0
    v_add_u32 v9, 114688, v8
    ds_read2_b32 v[80:81], v9 offset0:0 offset1:2
    ds_read2_b32 v[88:89], v9 offset0:1 offset1:3
    v_add_u32 v9, 1024, v9
    ds_read2_b32 v[82:83], v9 offset0:0 offset1:2
    ds_read2_b32 v[90:91], v9 offset0:1 offset1:3
    v_add_u32 v9, 1024, v9
    ds_read2_b32 v[84:85], v9 offset0:0 offset1:2
    ds_read2_b32 v[92:93], v9 offset0:1 offset1:3
    v_add_u32 v9, 1024, v9
    ds_read2_b32 v[86:87], v9 offset0:0 offset1:2
    ds_read2_b32 v[94:95], v9 offset0:1 offset1:3
    s_mov_b32 exec_lo, 0x10001
    s_mov_b32 exec_hi, 0x10001
    ds_read_b128 v[144:147], v226 offset:20480
    ds_read_b128 v[152:155], v226 offset:20608
    s_mov_b64 exec, -1
    s_branch L_tgo
L_tretry:
    buffer_load_dwordx4 v[16:19], v5, s[8:11], s58 offen sc1
    buffer_load_dwordx4 v[20:23], v5, s[8:11], s59 offen sc1
    buffer_load_dwordx4 v[24:27], v5, s[8:11], s60 offen sc1
    buffer_load_dwordx4 v[28:31], v5, s[8:11], s61 offen sc1
    buffer_load_dwordx4 v[32:35], v5, s[8:11], s62 offen sc1
    buffer_load_dwordx4 v[36:39], v5, s[8:11], s63 offen sc1
    buffer_load_dwordx4 v[40:43], v5, s[8:11], s64 offen sc1
    buffer_load_dwordx4 v[44:47], v5, s[8:11], s65 offen sc1
L_tgo:
    s_setprio 2
    v_mov_b32 v10, 0
    s_waitcnt lgkmcnt(0)
    s_waitcnt vmcnt(4)
    v_xor_b32 v176, v236, v16
    v_xor_b32 v177, v236, v20
    v_xor_b32 v178, v236, v24
    v_xor_b32 v179, v236, v28
    v_xor_b32 v180, v237, v17
    v_xor_b32 v181, v237, v21
    v_xor_b32 v182, v237, v25
    v_xor_b32 v183, v237, v29
    v_mfma_f32_16x16x32_f16 v[96:99], v[176:179], v[80:83], v[112:115]
    v_or3_b32 v10, v10, v176, v177
    v_mfma_f32_16x16x32_f16 v[48:51], v[176:179], v[88:91], 0
    v_or3_b32 v10, v10, v178, v179
    v_xor_b32 v184, v238, v18
    v_xor_b32 v185, v238, v22
    v_xor_b32 v186, v238, v26
    v_xor_b32 v187, v238, v30
    v_mfma_f32_16x16x32_f16 v[100:103], v[180:183], v[80:83], v[116:119]
    v_or3_b32 v10, v10, v180, v181
    v_mfma_f32_16x16x32_f16 v[52:55], v[180:183], v[88:91], 0
    v_or3_b32 v10, v10, v182, v183
    v_xor_b32 v188, v239, v19
    v_xor_b32 v189, v239, v23
    v_xor_b32 v190, v239, v27
    v_xor_b32 v191, v239, v31
    v_mfma_f32_16x16x32_f16 v[104:107], v[184:187], v[80:83], v[120:123]
    v_or3_b32 v10, v10, v184, v185
    v_mfma_f32_16x16x32_f16 v[56:59], v[184:187], v[88:91], 0
    v_or3_b32 v10, v10, v186, v187
    v_mfma_f32_16x16x32_f16 v[108:111], v[188:191], v[80:83], v[124:127]
    v_or3_b32 v10, v10, v188, v189
    v_mfma_f32_16x16x32_f16 v[60:63], v[188:191], v[88:91], 0
    v_or3_b32 v10, v10, v190, v191
    s_waitcnt vmcnt(0)
    v_xor_b32 v192, v236, v32
    v_xor_b32 v193, v236, v36
    v_xor_b32 v194, v236, v40
    v_xor_b32 v195, v236, v44
    v_xor_b32 v196, v237, v33
    v_xor_b32 v197, v237, v37
    v_xor_b32 v198, v237, v41
    v_xor_b32 v199, v237, v45
    v_mfma_f32_16x16x32_f16 v[96:99], v[192:195], v[84:87], v[96:99]
    v_or3_b32 v10, v10, v192, v193
    v_mfma_f32_16x16x32_f16 v[48:51], v[192:195], v[92:95], v[48:51]
    v_or3_b32 v10, v10, v194, v195
    v_xor_b32 v200, v238, v34
    v_xor_b32 v201, v238, v38
    v_xor_b32 v202, v238, v42
    v_xor_b32 v203, v238, v46
    v_mfma_f32_16x16x32_f16 v[100:103], v[196:199], v[84:87], v[100:103]
    v_or3_b32 v10, v10, v196, v197
    v_mfma_f32_16x16x32_f16 v[52:55], v[196:199], v[92:95], v[52:55]
    v_or3_b32 v10, v10, v198, v199
    v_xor_b32 v204, v239, v35
    v_xor_b32 v205, v239, v39
    v_xor_b32 v206, v239, v43
    v_xor_b32 v207, v239, v47
    v_mfma_f32_16x16x32_f16 v[104:107], v[200:203], v[84:87], v[104:107]
    v_or3_b32 v10, v10, v200, v201
    v_mfma_f32_16x16x32_f16 v[56:59], v[200:203], v[92:95], v[56:59]
    v_or3_b32 v10, v10, v202, v203
    v_mfma_f32_16x16x32_f16 v[108:111], v[204:207], v[84:87], v[108:111]
    v_or3_b32 v10, v10, v204, v205
    v_mfma_f32_16x16x32_f16 v[60:63], v[204:207], v[92:95], v[60:63]
    v_or3_b32 v10, v10, v206, v207
    v_and_b32 v10, 0x10001, v10
    v_cmp_ne_u32 vcc, 0, v10
    s_nop 0
    s_cbranch_vccnz L_tok_r
L_tok:
    v_pk_add_f32 v[96:97], v[96:97], v[50:51]
    v_pk_add_f32 v[100:101], v[100:101], v[54:55]
    v_pk_add_f32 v[104:105], v[104:105], v[58:59]
    v_pk_add_f32 v[108:109], v[108:109], v[62:63]
    v_cvt_pk_bf16_f32 v160, v96, v97
    v_cvt_pk_bf16_f32 v161, v100, v101
    v_cvt_pk_bf16_f32 v162, v104, v105
    v_cvt_pk_bf16_f32 v163, v108, v109
    v_pk_add_f32 v[96:97], v[96:97], v[128:129]
    v_pk_add_f32 v[100:101], v[100:101], v[130:131]
    v_pk_add_f32 v[104:105], v[104:105], v[132:133]
    v_pk_add_f32 v[108:109], v[108:109], v[134:135]
    v_cndmask_b32 v109, v109, v136, s[52:53]
    v_mfma_f32_16x16x32_bf16 v[208:211], v[160:163], v[160:163], 0
    v_mfma_f32_16x16x32_bf16 v[212:215], v[144:147], v[160:163], 0
    v_cvt_pk_bf16_f32 v168, v96, v97
    v_cvt_pk_bf16_f32 v169, v100, v101
    v_cvt_pk_bf16_f32 v170, v104, v105
    v_cvt_pk_bf16_f32 v171, v108, v109
    s_nop 1
    v_mfma_f32_16x16x32_bf16 v[216:219], v[168:171], v[168:171], 0
    v_mfma_f32_16x16x32_bf16 v[220:223], v[152:155], v[168:171], 0
    s_mov_b32 exec_lo, 0x00f0000f
    s_mov_b32 exec_hi, 0xf0000f00
    ds_write_b128 v230, v[208:211]
    s_nop 3
    ds_write_b128 v230, v[216:219] offset:384
    s_mov_b64 exec, 0xffff
    ds_write_b64 v231, v[212:213] offset:256
    ds_write_b64 v231, v[220:221] offset:640
    s_mov_b64 exec, -1
    s_waitcnt lgkmcnt(0)
    s_barrier
    ds_write_b16 v224, v160 offset:0
    ds_write_b16 v225, v168 offset:432
    ds_write_b16_d16_hi v224, v160 offset:64
    ds_write_b16_d16_hi v225, v168 offset:368
    ds_write_b16 v224, v161 offset:16
    ds_write_b16 v225, v169 offset:416
    ds_write_b16_d16_hi v224, v161 offset:80
    ds_write_b16_d16_hi v225, v169 offset:352
    ds_write_b16 v224, v162 offset:32
    ds_write_b16 v225, v170 offset:400
    ds_write_b16_d16_hi v224, v162 offset:96
    ds_write_b16_d16_hi v225, v170 offset:336
    ds_write_b16 v224, v163 offset:48
    ds_write_b16 v225, v171 offset:384
    ds_write_b16_d16_hi v224, v163 offset:112
    ds_write_b16_d16_hi v228, v171
    s_branch L_out
L_tok_r:
    s_add_u32 s50, s50, 1
    s_cmp_gt_u32 s50, 65536
    s_cbranch_scc1 L_tok
    s_branch L_tretry
.p2align 12
L_M:
    ds_read_b128 v[156:159], v8 offset:12288
    ds_read_b128 v[160:163], v8 offset:13312
    ds_read_b128 v[164:167], v8 offset:14336
    ds_read_b128 v[168:171], v8 offset:15360
    ds_read_b128 v[172:175], v8 offset:16384
    ds_read_b128 v[176:179], v8 offset:17408
    ds_read_b128 v[180:183], v8 offset:18432
    ds_read_b128 v[184:187], v8 offset:19456
    ds_read_b128 v[188:191], v8 offset:20480
    ds_read_b128 v[192:195], v8 offset:21504
    ds_read_b128 v[196:199], v8 offset:22528
    ds_read_b128 v[200:203], v8 offset:23552
    ds_read_b128 v[204:207], v8 offset:24576
    ds_read_b128 v[208:211], v8 offset:25600
    ds_read_b128 v[212:215], v8 offset:26624
    ds_read_b128 v[216:219], v8 offset:27648
    ds_read_b128 v[220:223], v8 offset:28672
    ds_read_b128 v[224:227], v8 offset:29696
    ds_read_b128 v[228:231], v8 offset:30720
    ds_read_b128 v[232:235], v8 offset:31744
    s_cmp_eq_u32 s33, 0
    s_cselect_b32 s53, 8, s33
    s_lshl_b32 s54, s44, 6
    s_add_u32 s53, s53, 256
    v_and_b32 v78, 7, v1
    v_lshl_add_u32 v78, v78, 3, s53
    v_lshrrev_b32 v80, 3, v1
    v_lshl_add_u32 v79, v2, 1, s54
    v_cvt_f32_u32 v80, v80
    v_mul_u32_u24 v79, v78, v79
    v_mul_f32 v80, 0xbe800000, v80
    v_cvt_f32_u32 v78, v78
    v_cvt_f32_u32 v79, v79
    v_mul_f32 v78, s45, v78
    v_fma_f32 v79, v79, s45, v80
    v_mul_f32 v76, 0x41000000, v78
    v_fract_f32 v32, v79
    v_add_f32 v34, v32, v78
    v_add_f32 v36, v32, v76
    v_add_f32 v38, v34, v76
    v_cos_f32 v76, v76
    v_sin_f32 v33, -v32
    v_cos_f32 v32, v32
    v_sin_f32 v35, -v34
    v_cos_f32 v34, v34
    v_sin_f32 v37, -v36
    v_cos_f32 v36, v36
    v_sin_f32 v39, -v38
    v_cos_f32 v38, v38
    v_add_f32 v76, v76, v76
    v_mov_b32 v77, v76
    v_cvt_pk_bf16_f32 v236, v32, v33
    v_cvt_pk_bf16_f32 v237, v34, v35
    v_cvt_pk_bf16_f32 v238, v36, v37
    v_cvt_pk_bf16_f32 v239, v38, v39
    v_pk_fma_f32 v[40:41], v[76:77], v[36:37], v[32:33] neg_lo:[0,0,1] neg_hi:[0,0,1]
    v_pk_fma_f32 v[42:43], v[76:77], v[38:39], v[34:35] neg_lo:[0,0,1] neg_hi:[0,0,1]
    v_pk_fma_f32 v[44:45], v[76:77], v[40:41], v[36:37] neg_lo:[0,0,1] neg_hi:[0,0,1]
    v_pk_fma_f32 v[46:47], v[76:77], v[42:43], v[38:39] neg_lo:[0,0,1] neg_hi:[0,0,1]
    v_cvt_pk_bf16_f32 v240, v40, v41
    v_cvt_pk_bf16_f32 v241, v42, v43
    v_cvt_pk_bf16_f32 v242, v44, v45
    v_cvt_pk_bf16_f32 v243, v46, v47
    v_pk_fma_f32 v[48:49], v[76:77], v[44:45], v[40:41] neg_lo:[0,0,1] neg_hi:[0,0,1]
    v_pk_fma_f32 v[50:51], v[76:77], v[46:47], v[42:43] neg_lo:[0,0,1] neg_hi:[0,0,1]
    v_pk_fma_f32 v[52:53], v[76:77], v[48:49], v[44:45] neg_lo:[0,0,1] neg_hi:[0,0,1]
    v_pk_fma_f32 v[54:55], v[76:77], v[50:51], v[46:47] neg_lo:[0,0,1] neg_hi:[0,0,1]
    v_cvt_pk_bf16_f32 v244, v48, v49
    v_cvt_pk_bf16_f32 v245, v50, v51
    v_cvt_pk_bf16_f32 v246, v52, v53
    v_cvt_pk_bf16_f32 v247, v54, v55
    v_pk_fma_f32 v[56:57], v[76:77], v[52:53], v[48:49] neg_lo:[0,0,1] neg_hi:[0,0,1]
    v_pk_fma_f32 v[58:59], v[76:77], v[54:55], v[50:51] neg_lo:[0,0,1] neg_hi:[0,0,1]
    v_pk_fma_f32 v[60:61], v[76:77], v[56:57], v[52:53] neg_lo:[0,0,1] neg_hi:[0,0,1]
    v_pk_fma_f32 v[62:63], v[76:77], v[58:59], v[54:55] neg_lo:[0,0,1] neg_hi:[0,0,1]
    v_cvt_pk_bf16_f32 v248, v56, v57
    v_cvt_pk_bf16_f32 v249, v58, v59
    v_cvt_pk_bf16_f32 v250, v60, v61
    v_cvt_pk_bf16_f32 v251, v62, v63
    v_pk_fma_f32 v[64:65], v[76:77], v[60:61], v[56:57] neg_lo:[0,0,1] neg_hi:[0,0,1]
    v_pk_fma_f32 v[66:67], v[76:77], v[62:63], v[58:59] neg_lo:[0,0,1] neg_hi:[0,0,1]
    v_pk_fma_f32 v[68:69], v[76:77], v[64:65], v[60:61] neg_lo:[0,0,1] neg_hi:[0,0,1]
    v_pk_fma_f32 v[70:71], v[76:77], v[66:67], v[62:63] neg_lo:[0,0,1] neg_hi:[0,0,1]
    v_cvt_pk_bf16_f32 v252, v64, v65
    v_cvt_pk_bf16_f32 v253, v66, v67
    v_cvt_pk_bf16_f32 v254, v68, v69
    v_cvt_pk_bf16_f32 v255, v70, v71
    v_mul_u32_u24 v9, 10, v2
    v_lshrrev_b32 v10, 1, v1
    v_xor_b32 v10, v10, v1
    v_bfe_u32 v10, v10, 2, 1
    v_and_or_b32 v10, v1, 6, v10
    v_lshl_add_u32 v11, v1, 7, s49
    v_xor_b32 v12, v9, v10
    v_and_b32 v96, 7, v12
    v_lshrrev_b32 v12, 3, v12
    v_lshl_add_u32 v96, v96, 4, v11
    v_lshl_add_u32 v96, v12, 11, v96
    v_xor_b32 v97, 16, v96
    v_add_u32 v9, 2, v9
    v_xor_b32 v12, v9, v10
    v_and_b32 v98, 7, v12
    v_lshrrev_b32 v12, 3, v12
    v_lshl_add_u32 v98, v98, 4, v11
    v_lshl_add_u32 v98, v12, 11, v98
    v_xor_b32 v99, 16, v98
    v_add_u32 v9, 2, v9
    v_xor_b32 v12, v9, v10
    v_and_b32 v100, 7, v12
    v_lshrrev_b32 v12, 3, v12
    v_lshl_add_u32 v100, v100, 4, v11
    v_lshl_add_u32 v100, v12, 11, v100
    v_xor_b32 v101, 16, v100
    v_add_u32 v9, 2, v9
    v_xor_b32 v12, v9, v10
    v_and_b32 v102, 7, v12
    v_lshrrev_b32 v12, 3, v12
    v_lshl_add_u32 v102, v102, 4, v11
    v_lshl_add_u32 v102, v12, 11, v102
    v_xor_b32 v103, 16, v102
    v_add_u32 v9, 2, v9
    v_xor_b32 v12, v9, v10
    v_and_b32 v104, 7, v12
    v_lshrrev_b32 v12, 3, v12
    v_lshl_add_u32 v104, v104, 4, v11
    v_lshl_add_u32 v104, v12, 11, v104
    v_xor_b32 v105, 16, v104
    v_mov_b32 v132, 0x3f803f80
    v_mov_b32 v133, 0x3f803f80
    v_mov_b32 v134, 0x3f803f80
    v_mov_b32 v135, 0x3f803f80
    v_and_b32 v9, 1, v1
    v_mul_u32_u24 v136, 0xaaaa, v9
    v_or_b32 v136, 0x4444, v136
    s_mov_b32 s60, 0x22222222
    s_mov_b32 s61, s60
    s_lshl_b64 s[62:63], s[60:61], 1
    s_lshl_b64 s[64:65], s[60:61], 2
    v_mul_u32_u24 v9, s33, v2
    v_and_b32 v10, 1, v1
    v_lshlrev_b32 v10, 1, v10
    v_sub_u32 v9, v9, v10
    v_cvt_f32_i32 v9, v9
    v_mul_f32 v9, 0x3e000000, v9
    v_cos_f32 v9, v9
    v_and_b32 v10, 2, v1
    v_lshlrev_b32 v10, 3, v10
    v_cvt_pk_bf16_f32 v9, v9, 0
    v_lshlrev_b32 v9, v10, v9
    v_lshrrev_b32 v10, 2, v1
    s_and_b32 s43, s33, 1
    s_mul_i32 s43, s43, 0x80008000
    v_cmp_eq_u32 vcc, 0, v10
    s_nop 1
    v_cndmask_b32 v108, 0, v9, vcc
    v_xor_b32 v112, s43, v108
    v_cmp_eq_u32 vcc, 1, v10
    s_nop 1
    v_cndmask_b32 v109, 0, v9, vcc
    v_xor_b32 v113, s43, v109
    v_cmp_eq_u32 vcc, 2, v10
    s_nop 1
    v_cndmask_b32 v110, 0, v9, vcc
    v_xor_b32 v114, s43, v110
    v_cmp_eq_u32 vcc, 3, v10
    s_nop 1
    v_cndmask_b32 v111, 0, v9, vcc
    v_xor_b32 v115, s43, v111
    v_mov_b32 v128, 0
    v_mov_b32 v129, 0
    v_mov_b32 v130, 0
    v_mov_b32 v131, 0
    s_waitcnt vmcnt(0)
    ds_read_b128 v[16:19], v96
    ds_read_b128 v[20:23], v97
    ds_read_b128 v[24:27], v98
    ds_read_b128 v[28:31], v99
    ds_read_b128 v[32:35], v100
    ds_read_b128 v[36:39], v101
    ds_read_b128 v[40:43], v102
    ds_read_b128 v[44:47], v103
    ds_read_b128 v[48:51], v104
    ds_read_b128 v[52:55], v105
    s_barrier
    s_waitcnt lgkmcnt(9)
    v_mfma_f32_16x16x32_bf16 v[56:59], v[108:111], v[16:19], 0
    v_lshrrev_b32 v9, 1, v1
    v_lshl_add_u32 v9, s46, 3, v9
    v_mfma_f32_16x16x32_bf16 v[124:127], v[16:19], v[16:19], 0
    v_and_b32 v11, 1, v1
    v_lshl_add_u32 v10, v9, 1, v11
    s_waitcnt lgkmcnt(8)
    v_mfma_f32_16x16x32_bf16 v[60:63], v[108:111], v[20:23], 0
    v_cmp_eq_u32 vcc, 1, v10
    s_nop 1
    v_cndmask_b32 v9, v9, 32, vcc
    v_mfma_f32_16x16x32_bf16 v[124:127], v[20:23], v[20:23], v[124:127]
    v_cndmask_b32 v11, v11, 0, vcc
    v_cvt_f32_u32 v9, v9
    v_smfmac_f32_16x16x64_bf16 v[128:131], v[132:135], v[16:23], v136
    v_cvt_f32_u32 v11, v11
    v_mul_f32 v9, 0x3c800000, v9
    s_waitcnt lgkmcnt(7)
    v_mfma_f32_16x16x32_bf16 v[64:67], v[108:111], v[24:27], 0
    v_mul_f32 v11, 0xbe800000, v11
    v_lshlrev_b32 v10, 3, v2
    v_mfma_f32_16x16x32_bf16 v[124:127], v[24:27], v[24:27], v[124:127]
    v_cvt_f32_u32 v10, v10
    v_cos_f32 v12, v9
    s_waitcnt lgkmcnt(6)
    v_mfma_f32_16x16x32_bf16 v[68:71], v[108:111], v[28:31], 0
    v_fma_f32 v138, v9, v10, v11
    v_add_f32 v10, 0x42000000, v10
    v_mfma_f32_16x16x32_bf16 v[124:127], v[28:31], v[28:31], v[124:127]
    v_fma_f32 v146, v9, v10, v11
    v_add_f32 v139, v138, v9
    v_smfmac_f32_16x16x64_bf16 v[128:131], v[132:135], v[24:31], v136
    v_add_f32 v147, v146, v9
    v_cos_f32 v138, v138
    s_waitcnt lgkmcnt(5)
    v_mfma_f32_16x16x32_bf16 v[72:75], v[108:111], v[32:35], 0
    v_cos_f32 v139, v139
    v_cos_f32 v146, v146
    v_mfma_f32_16x16x32_bf16 v[124:127], v[32:35], v[32:35], v[124:127]
    v_cos_f32 v147, v147
    v_add_f32 v12, v12, v12
    s_waitcnt lgkmcnt(4)
    v_mfma_f32_16x16x32_bf16 v[76:79], v[108:111], v[36:39], 0
    v_fma_f32 v140, v12, v139, -v138
    v_fma_f32 v148, v12, v147, -v146
    v_mfma_f32_16x16x32_bf16 v[124:127], v[36:39], v[36:39], v[124:127]
    v_fma_f32 v141, v12, v140, -v139
    v_fma_f32 v149, v12, v148, -v147
    v_smfmac_f32_16x16x64_bf16 v[128:131], v[132:135], v[32:39], v136
    v_fma_f32 v142, v12, v141, -v140
    v_fma_f32 v150, v12, v149, -v148
    s_waitcnt lgkmcnt(3)
    v_mfma_f32_16x16x32_bf16 v[80:83], v[108:111], v[40:43], 0
    v_fma_f32 v143, v12, v142, -v141
    v_fma_f32 v151, v12, v150, -v149
    v_mfma_f32_16x16x32_bf16 v[124:127], v[40:43], v[40:43], v[124:127]
    v_fma_f32 v144, v12, v143, -v142
    v_fma_f32 v152, v12, v151, -v150
    s_waitcnt lgkmcnt(2)
    v_mfma_f32_16x16x32_bf16 v[84:87], v[108:111], v[44:47], 0
    v_fma_f32 v145, v12, v144, -v143
    v_fma_f32 v153, v12, v152, -v151
    v_mfma_f32_16x16x32_bf16 v[124:127], v[44:47], v[44:47], v[124:127]
    v_cvt_pk_f16_f32 v116, v138, v139
    v_cvt_pk_f16_f32 v117, v140, v141
    v_smfmac_f32_16x16x64_bf16 v[128:131], v[132:135], v[40:47], v136
    v_cvt_pk_f16_f32 v118, v142, v143
    v_cvt_pk_f16_f32 v119, v144, v145
    s_waitcnt lgkmcnt(1)
    v_mfma_f32_16x16x32_bf16 v[88:91], v[108:111], v[48:51], 0
    v_cvt_pk_f16_f32 v120, v146, v147
    v_cvt_pk_f16_f32 v121, v148, v149
    v_mfma_f32_16x16x32_bf16 v[124:127], v[48:51], v[48:51], v[124:127]
    v_cvt_pk_f16_f32 v122, v150, v151
    v_cvt_pk_f16_f32 v123, v152, v153
    s_waitcnt lgkmcnt(0)
    v_mfma_f32_16x16x32_bf16 v[92:95], v[108:111], v[52:55], 0
    v_mfma_f32_16x16x32_bf16 v[124:127], v[52:55], v[52:55], v[124:127]
    v_smfmac_f32_16x16x64_bf16 v[128:131], v[132:135], v[48:55], v136
    s_cmp_lg_u32 s33, 0
    s_cbranch_scc1 L_nooff
    s_nop 5
    v_add_f32 v9, v128, v129
    v_mul_f32 v9, 0xbccccccd, v9
    v_add_f32 v56, v56, v9
    v_add_f32 v58, v58, v9
    v_add_f32 v60, v60, v9
    v_add_f32 v62, v62, v9
    v_add_f32 v64, v64, v9
    v_add_f32 v66, v66, v9
    v_add_f32 v68, v68, v9
    v_add_f32 v70, v70, v9
    v_add_f32 v72, v72, v9
    v_add_f32 v74, v74, v9
    v_add_f32 v76, v76, v9
    v_add_f32 v78, v78, v9
    v_add_f32 v80, v80, v9
    v_add_f32 v82, v82, v9
    v_add_f32 v84, v84, v9
    v_add_f32 v86, v86, v9
    v_add_f32 v88, v88, v9
    v_add_f32 v90, v90, v9
    v_add_f32 v92, v92, v9
    v_add_f32 v94, v94, v9
L_nooff:
    s_setprio 2
    s_barrier
    ds_read_b128 v[16:19], v96 offset:10240
    ds_read_b128 v[20:23], v97 offset:10240
    ds_read_b128 v[24:27], v98 offset:10240
    ds_read_b128 v[28:31], v99 offset:10240
    ds_read_b128 v[32:35], v100 offset:10240
    ds_read_b128 v[36:39], v101 offset:10240
    ds_read_b128 v[40:43], v102 offset:10240
    ds_read_b128 v[44:47], v103 offset:10240
    ds_read_b128 v[48:51], v104 offset:10240
    ds_read_b128 v[52:55], v105 offset:10240
    s_waitcnt lgkmcnt(9)
    v_mfma_f32_16x16x32_bf16 v[56:59], v[112:115], v[16:19], v[56:59]
    v_and_b32 v148, 7, v1
    v_lshlrev_b32 v148, 4, v148
    v_mfma_f32_16x16x32_bf16 v[124:127], v[16:19], v[16:19], v[124:127]
    v_lshl_add_u32 v148, v1, 7, v148
    v_lshlrev_b32 v142, 5, v3
    s_waitcnt lgkmcnt(8)
    v_mfma_f32_16x16x32_bf16 v[60:63], v[112:115], v[20:23], v[60:63]
    v_lshl_add_u32 v142, v2, 3, v142
    v_xor_b32 v142, v142, v148
    v_mfma_f32_16x16x32_bf16 v[124:127], v[20:23], v[20:23], v[124:127]
    v_lshlrev_b32 v143, 4, v2
    v_xor_b32 v143, v143, v148
    v_smfmac_f32_16x16x64_bf16 v[128:131], v[132:135], v[16:23], v136
    v_xor_b32 v148, 64, v143
    v_lshlrev_b32 v144, 17, v2
    s_waitcnt lgkmcnt(7)
    v_mfma_f32_16x16x32_bf16 v[64:67], v[112:115], v[24:27], v[64:67]
    v_lshl_add_u32 v144, v1, 4, v144
    v_lshlrev_b32 v145, 15, v2
    v_mfma_f32_16x16x32_bf16 v[124:127], v[24:27], v[24:27], v[124:127]
    v_lshl_add_u32 v145, v1, 2, v145
    s_mov_b32 s55, 0xfffefffe
    s_waitcnt lgkmcnt(6)
    v_mfma_f32_16x16x32_bf16 v[68:71], v[112:115], v[28:31], v[68:71]
    v_cvt_pk_bf16_f32 v56, v56, v57
    v_cvt_pk_bf16_f32 v57, v58, v59
    v_mfma_f32_16x16x32_bf16 v[124:127], v[28:31], v[28:31], v[124:127]
    v_cvt_pk_bf16_f32 v58, v60, v61
    v_cvt_pk_bf16_f32 v59, v62, v63
    v_smfmac_f32_16x16x64_bf16 v[128:131], v[132:135], v[24:31], v136
    v_and_b32 v146, 3, v1
    v_lshlrev_b32 v146, 4, v146
    s_waitcnt lgkmcnt(5)
    v_mfma_f32_16x16x32_bf16 v[72:75], v[112:115], v[32:35], v[72:75]
    v_lshlrev_b32 v149, 2, v1
    v_mov_b32 v13, 0
    v_mfma_f32_16x16x32_bf16 v[124:127], v[32:35], v[32:35], v[124:127]
    s_lshl_b32 s52, s46, 19
    s_lshl_b32 s43, s32, 11
    s_waitcnt lgkmcnt(4)
    v_mfma_f32_16x16x32_bf16 v[76:79], v[112:115], v[36:39], v[76:79]
    v_cvt_pk_bf16_f32 v64, v64, v65
    v_cvt_pk_bf16_f32 v65, v66, v67
    v_mfma_f32_16x16x32_bf16 v[124:127], v[36:39], v[36:39], v[124:127]
    v_cvt_pk_bf16_f32 v66, v68, v69
    v_cvt_pk_bf16_f32 v67, v70, v71
    v_smfmac_f32_16x16x64_bf16 v[128:131], v[132:135], v[32:39], v136
    s_add_u32 s52, s52, s43
    s_lshl_b32 s43, s33, 8
    s_waitcnt lgkmcnt(3)
    v_mfma_f32_16x16x32_bf16 v[80:83], v[112:115], v[40:43], v[80:83]
    s_add_u32 s52, s52, s43
    s_lshr_b32 s56, s52, 2
    v_mfma_f32_16x16x32_bf16 v[124:127], v[40:43], v[40:43], v[124:127]
    s_add_u32 s52, s52, 131072
    s_add_u32 s53, s52, 65536
    s_waitcnt lgkmcnt(2)
    v_mfma_f32_16x16x32_bf16 v[84:87], v[112:115], v[44:47], v[84:87]
    v_cvt_pk_bf16_f32 v72, v72, v73
    v_cvt_pk_bf16_f32 v73, v74, v75
    v_mfma_f32_16x16x32_bf16 v[124:127], v[44:47], v[44:47], v[124:127]
    v_cvt_pk_bf16_f32 v74, v76, v77
    v_cvt_pk_bf16_f32 v75, v78, v79
    v_smfmac_f32_16x16x64_bf16 v[128:131], v[132:135], v[40:47], v136
    s_add_u32 s56, s56, 2228224
    s_add_u32 s57, s56, 16384
    s_waitcnt lgkmcnt(1)
    v_mfma_f32_16x16x32_bf16 v[88:91], v[112:115], v[48:51], v[88:91]
    v_mfma_f32_16x16x32_bf16 v[124:127], v[48:51], v[48:51], v[124:127]
    s_waitcnt lgkmcnt(0)
    v_mfma_f32_16x16x32_bf16 v[92:95], v[112:115], v[52:55], v[92:95]
    v_cvt_pk_bf16_f32 v80, v80, v81
    v_cvt_pk_bf16_f32 v81, v82, v83
    v_mfma_f32_16x16x32_bf16 v[124:127], v[52:55], v[52:55], v[124:127]
    v_cvt_pk_bf16_f32 v82, v84, v85
    v_cvt_pk_bf16_f32 v83, v86, v87
    v_smfmac_f32_16x16x64_bf16 v[128:131], v[132:135], v[48:55], v136
    v_mfma_f32_16x16x32_bf16 v[16:19], v[56:59], v[156:159], 0
    v_mfma_f32_16x16x32_bf16 v[20:23], v[56:59], v[176:179], 0
    v_mfma_f32_16x16x32_bf16 v[24:27], v[56:59], v[196:199], 0
    v_cvt_pk_bf16_f32 v88, v88, v89
    v_cvt_pk_bf16_f32 v89, v90, v91
    v_mfma_f32_16x16x32_bf16 v[28:31], v[56:59], v[216:219], 0
    v_cvt_pk_bf16_f32 v90, v92, v93
    v_cvt_pk_bf16_f32 v91, v94, v95
    v_mfma_f32_16x16x32_bf16 v[32:35], v[56:59], v[236:239], 0
    v_add_f32 v128, v128, v129
    v_cndmask_b32 v124, v124, v125, s[60:61]
    v_mfma_f32_16x16x32_bf16 v[16:19], v[64:67], v[160:163], v[16:19]
    v_mul_f32 v128, s45, v128
    v_cndmask_b32 v124, v124, v126, s[62:63]
    v_mfma_f32_16x16x32_bf16 v[20:23], v[64:67], v[180:183], v[20:23]
    v_mul_f32 v128, v128, v128
    v_cndmask_b32 v124, v124, v127, s[64:65]
    v_mfma_f32_16x16x32_bf16 v[24:27], v[64:67], v[200:203], v[24:27]
    v_fma_f32 v124, v124, s45, -v128
    v_max_f32 v124, 0, v124
    v_mfma_f32_16x16x32_bf16 v[28:31], v[64:67], v[220:223], v[28:31]
    v_cvt_pk_bf16_f32 v124, 0, v124
    v_add_f32 v124, 0x3727c5ac, v124
    v_mfma_f32_16x16x32_bf16 v[32:35], v[64:67], v[240:243], v[32:35]
    v_cvt_pk_bf16_f32 v124, 0, v124
    v_sqrt_f32 v124, v124
    v_mfma_f32_16x16x32_bf16 v[16:19], v[72:75], v[164:167], v[16:19]
    v_cvt_pk_bf16_f32 v124, 0, v124
    v_mfma_f32_16x16x32_bf16 v[20:23], v[72:75], v[184:187], v[20:23]
    v_rcp_f32 v124, v124
    v_mfma_f32_16x16x32_bf16 v[24:27], v[72:75], v[204:207], v[24:27]
    s_nop 0
    v_mov_b32_dpp v138, v124 row_newbcast:0 row_mask:0x1 bank_mask:0xf
    v_mfma_f32_16x16x32_bf16 v[28:31], v[72:75], v[224:227], v[28:31]
    v_mov_b32_dpp v139, v124 row_newbcast:1 row_mask:0x1 bank_mask:0xf
    v_mov_b32_dpp v140, v124 row_newbcast:2 row_mask:0x1 bank_mask:0xf
    v_mfma_f32_16x16x32_bf16 v[32:35], v[72:75], v[244:247], v[32:35]
    v_mov_b32_dpp v141, v124 row_newbcast:3 row_mask:0x1 bank_mask:0xf
    v_mov_b32_dpp v138, v124 row_newbcast:4 row_mask:0x2 bank_mask:0xf
    v_mfma_f32_16x16x32_bf16 v[16:19], v[80:83], v[168:171], v[16:19]
    v_mov_b32_dpp v139, v124 row_newbcast:5 row_mask:0x2 bank_mask:0xf
    v_mov_b32_dpp v140, v124 row_newbcast:6 row_mask:0x2 bank_mask:0xf
    v_mfma_f32_16x16x32_bf16 v[20:23], v[80:83], v[188:191], v[20:23]
    v_mov_b32_dpp v141, v124 row_newbcast:7 row_mask:0x2 bank_mask:0xf
    v_mov_b32_dpp v138, v124 row_newbcast:8 row_mask:0x4 bank_mask:0xf
    v_mfma_f32_16x16x32_bf16 v[24:27], v[80:83], v[208:211], v[24:27]
    v_mov_b32_dpp v139, v124 row_newbcast:9 row_mask:0x4 bank_mask:0xf
    v_mov_b32_dpp v140, v124 row_newbcast:10 row_mask:0x4 bank_mask:0xf
    v_mfma_f32_16x16x32_bf16 v[28:31], v[80:83], v[228:231], v[28:31]
    v_mov_b32_dpp v141, v124 row_newbcast:11 row_mask:0x4 bank_mask:0xf
    v_mov_b32_dpp v138, v124 row_newbcast:12 row_mask:0x8 bank_mask:0xf
    v_mfma_f32_16x16x32_bf16 v[32:35], v[80:83], v[248:251], v[32:35]
    v_mov_b32_dpp v139, v124 row_newbcast:13 row_mask:0x8 bank_mask:0xf
    v_mov_b32_dpp v140, v124 row_newbcast:14 row_mask:0x8 bank_mask:0xf
    v_mfma_f32_16x16x32_bf16 v[16:19], v[88:91], v[172:175], v[16:19]
    v_mov_b32_dpp v141, v124 row_newbcast:15 row_mask:0x8 bank_mask:0xf
    v_mfma_f32_16x16x32_bf16 v[20:23], v[88:91], v[192:195], v[20:23]
    v_mfma_f32_16x16x32_bf16 v[24:27], v[88:91], v[212:215], v[24:27]
    v_mfma_f32_16x16x32_bf16 v[28:31], v[88:91], v[232:235], v[28:31]
    v_mfma_f32_16x16x32_bf16 v[32:35], v[88:91], v[252:255], v[32:35]
    s_nop 2
    v_pk_mul_f32 v[16:17], v[16:17], v[138:139]
    v_pk_mul_f32 v[18:19], v[18:19], v[140:141]
    v_cvt_pk_f16_f32 v36, v16, v17
    v_cvt_pk_f16_f32 v37, v18, v19
    ds_write_b64 v142, v[36:37] offset:2048
    v_pk_mul_f32 v[20:21], v[20:21], v[138:139]
    v_pk_mul_f32 v[22:23], v[22:23], v[140:141]
    v_cvt_pk_f16_f32 v38, v20, v21
    v_cvt_pk_f16_f32 v39, v22, v23
    ds_write_b64 v142, v[38:39] offset:4096
    v_pk_mul_f32 v[24:25], v[24:25], v[138:139]
    v_pk_mul_f32 v[26:27], v[26:27], v[140:141]
    v_cvt_pk_f16_f32 v40, v24, v25
    v_cvt_pk_f16_f32 v41, v26, v27
    ds_write_b64 v142, v[40:41] offset:6144
    v_pk_mul_f32 v[28:29], v[28:29], v[138:139]
    v_pk_mul_f32 v[30:31], v[30:31], v[140:141]
    v_cvt_pk_f16_f32 v42, v28, v29
    v_cvt_pk_f16_f32 v43, v30, v31
    ds_write_b64 v142, v[42:43] offset:8192
    v_pk_mul_f32 v[32:33], v[32:33], v[138:139]
    v_pk_mul_f32 v[34:35], v[34:35], v[140:141]
    v_cvt_pk_f16_f32 v44, v32, v33
    v_cvt_pk_f16_f32 v45, v34, v35
    ds_write_b64 v142, v[44:45] offset:10240
    s_waitcnt lgkmcnt(0)
    s_barrier
    ds_read_b128 v[16:19], v143 offset:2048
    ds_read_b128 v[20:23], v148 offset:2048
    ds_read_b128 v[24:27], v143 offset:4096
    ds_read_b128 v[28:31], v148 offset:4096
    ds_read_b128 v[32:35], v143 offset:6144
    ds_read_b128 v[36:39], v148 offset:6144
    ds_read_b128 v[150:153], v146 offset:64
    ds_read_b128 v[40:43], v143 offset:8192
    ds_read_b128 v[44:47], v148 offset:8192
    ds_read_b128 v[48:51], v143 offset:10240
    ds_read_b128 v[52:55], v148 offset:10240
    ds_read_b32 v147, v149 offset:64
    ds_read_b32 v14, v13 offset:4
    s_waitcnt lgkmcnt(11)
    v_mfma_f32_16x16x32_f16 v[70:73], v[116:119], v[16:19], 0
    v_mfma_f32_16x16x32_f16 v[70:73], v[120:123], v[20:23], v[70:73]
    s_waitcnt lgkmcnt(9)
    v_mfma_f32_16x16x32_f16 v[74:77], v[116:119], v[24:27], 0
    v_mfma_f32_16x16x32_f16 v[74:77], v[120:123], v[28:31], v[74:77]
    s_waitcnt lgkmcnt(6)
    v_mfma_f32_16x16x32_f16 v[78:81], v[116:119], v[32:35], 0
    v_mfma_f32_16x16x32_f16 v[78:81], v[120:123], v[36:39], v[78:81]
    s_nop 1
    v_cvt_pk_f16_f32 v92, v70, v71
    v_and_or_b32 v92, v92, s55, v150
    v_cvt_pk_f16_f32 v96, v72, v73
    v_and_or_b32 v96, v96, s55, v150
    s_waitcnt lgkmcnt(4)
    v_mfma_f32_16x16x32_f16 v[82:85], v[116:119], v[40:43], 0
    v_mfma_f32_16x16x32_f16 v[82:85], v[120:123], v[44:47], v[82:85]
    v_cvt_pk_f16_f32 v93, v74, v75
    v_and_or_b32 v93, v93, s55, v151
    v_cvt_pk_f16_f32 v97, v76, v77
    v_and_or_b32 v97, v97, s55, v151
    s_waitcnt lgkmcnt(0)
    v_mfma_f32_16x16x32_f16 v[86:89], v[116:119], v[48:51], 0
    v_mfma_f32_16x16x32_f16 v[86:89], v[120:123], v[52:55], v[86:89]
    v_cvt_pk_f16_f32 v94, v78, v79
    v_and_or_b32 v94, v94, s55, v152
    v_cvt_pk_f16_f32 v98, v80, v81
    v_and_or_b32 v98, v98, s55, v152
    v_cvt_pk_f16_f32 v95, v82, v83
    v_and_or_b32 v95, v95, s55, v153
    buffer_store_dwordx4 v[92:95], v144, s[8:11], s52 offen sc1
    v_cvt_pk_f16_f32 v99, v84, v85
    v_and_or_b32 v99, v99, s55, v153
    buffer_store_dwordx4 v[96:99], v144, s[8:11], s53 offen sc1
    v_cvt_pk_f16_f32 v100, v86, v87
    v_and_or_b32 v100, v100, s55, v147
    buffer_store_dword v100, v145, s[8:11], s56 offen sc1
    v_cvt_pk_f16_f32 v101, v88, v89
    v_and_or_b32 v101, v101, s55, v147
    buffer_store_dword v101, v145, s[8:11], s57 offen sc1
    s_setprio 0
    s_mov_b64 s[12:13], s[26:27]
    s_mov_b64 s[16:17], s[18:19]
    s_mov_b64 s[28:29], s[24:25]
    s_mov_b64 s[24:25], s[22:23]
    s_mov_b32 s14, 2621440
    s_mov_b32 s15, 0x20000
    s_mov_b32 s18, 1280
    s_mov_b32 s19, 0x20000
    s_mov_b32 s22, 2211840
    s_mov_b32 s23, 0x20000
    s_mov_b32 s26, 2211840
    s_mov_b32 s27, 0x20000
    s_mov_b32 s30, 2211840
    s_mov_b32 s31, 0x20000
    v_lshlrev_b32 v6, 2, v4
    v_mov_b32 v13, 0
    s_and_b32 s43, s33, 3
    s_lshr_b32 s35, s2, 6
    s_lshl3_add_u32 s35, s35, s37
    s_lshl2_add_u32 s35, s35, s43
    s_cmp_eq_u32 s32, 0
    s_cselect_b32 s39, 32, 64
    s_lshl_b32 s38, s39, 3
    s_mul_i32 s38, s38, s43
    s_add_u32 s38, s38, s32
    s_cmp_ge_u32 s33, 4
    s_cbranch_scc1 L_ffn
    s_branch L_prep
L_rare:
L_zretry:
    buffer_load_dwordx4 v[16:19], v5, s[8:11], s58 offen sc1
    buffer_load_dwordx4 v[20:23], v7, s[8:11], s58 offen sc1
    buffer_load_dwordx4 v[24:27], v5, s[8:11], s59 offen sc1
    buffer_load_dwordx4 v[28:31], v7, s[8:11], s59 offen sc1
    buffer_load_dwordx4 v[32:35], v5, s[8:11], s60 offen sc1
    buffer_load_dwordx4 v[36:39], v7, s[8:11], s60 offen sc1
    buffer_load_dwordx4 v[40:43], v5, s[8:11], s61 offen sc1
    buffer_load_dwordx4 v[44:47], v7, s[8:11], s61 offen sc1
    buffer_load_dwordx4 v[48:51], v5, s[8:11], s62 offen sc1
    buffer_load_dwordx4 v[52:55], v7, s[8:11], s62 offen sc1
    buffer_load_dwordx4 v[56:59], v5, s[8:11], s63 offen sc1
    buffer_load_dwordx4 v[60:63], v7, s[8:11], s63 offen sc1
    buffer_load_dwordx4 v[64:67], v5, s[8:11], s64 offen sc1
    buffer_load_dwordx4 v[68:71], v7, s[8:11], s64 offen sc1
    buffer_load_dwordx4 v[72:75], v5, s[8:11], s65 offen sc1
    buffer_load_dwordx4 v[76:79], v7, s[8:11], s65 offen sc1
    s_branch L_zgo
L_zok_r:
    s_add_u32 s50, s50, 1
    s_cmp_gt_u32 s50, 65536
    s_cbranch_scc1 L_zok
    s_branch L_zretry
.p2align 12
L_prep:
    v_mov_b32 v5, 0
    v_mov_b32 v7, 0
    s_add_u32 s69, s34, -2
    s_cmp_lt_u32 s69, 2
    s_cbranch_scc1 L_pub0
    s_cmp_lt_u32 s34, 2
    s_cbranch_scc1 L_ztail
    v_lshlrev_b32 v5, 11, v2
    v_lshrrev_b32 v10, 3, v1
    s_add_u32 s49, s46, s33
    s_and_b32 s49, s49, 3
    v_lshl_add_u32 v10, s49, 1, v10
    v_lshl_add_u32 v5, v10, 8, v5
    v_and_b32 v9, 7, v1
    v_lshl_add_u32 v5, v9, 4, v5
    v_add_u32 v7, 128, v5
    v_lshrrev_b32 v10, 1, v2
    v_lshl_add_u32 v10, s49, 1, v10
    v_and_b32 v9, 1, v2
    v_lshlrev_b32 v9, 5, v9
    s_lshl_b32 s58, s32, 16
    s_add_u32 s58, s58, 131072
    s_movk_i32 s48, 8192
    s_add_u32 s51, s46, 2
    s_branch L_zcom
L_ztail:
    v_lshl_add_u32 v10, s34, 2, v2
    v_lshlrev_b32 v5, 9, v2
    v_lshl_add_u32 v5, v1, 4, v5
    v_lshl_add_u32 v5, s34, 8, v5
    s_lshl_b32 s58, s32, 14
    s_add_u32 s58, s58, 2228224
    s_movk_i32 s48, 2048
    v_mov_b32 v9, 256
    s_mov_b32 s51, s34
L_zcom:
    v_and_b32 v11, 3, v1
    v_lshlrev_b32 v11, 4, v11
    ds_read_b128 v[236:239], v11 offset:64
    s_add_u32 s59, s58, s48
    s_add_u32 s60, s59, s48
    s_add_u32 s61, s60, s48
    s_add_u32 s62, s61, s48
    s_add_u32 s63, s62, s48
    s_add_u32 s64, s63, s48
    s_add_u32 s65, s64, s48
    s_mul_i32 s40, s34, s39
    s_add_u32 s40, s40, s38
    s_sub_u32 s41, 2048, s40
    s_cmp_eq_u32 s40, 0
    s_cselect_b32 s41, 1024, s41
    s_mul_i32 s56, s40, 1280
    s_mul_i32 s57, s41, 1280
    s_mul_i32 s49, s34, 1284
    s_add_u32 s49, s49, 118784
    v_add_u32 v233, s49, v6
    v_lshlrev_b32 v234, 3, v3
    s_cmp_eq_u32 s38, 0
    s_cselect_b32 s47, 0, 8
    v_add_u32 v10, -1, v10
    v_and_b32 v10, 7, v10
    v_add3_u32 v9, v9, v10, 1
    v_lshlrev_b32 v9, 1, v9
    v_and_b32 v10, 7, v1
    v_mov_b32 v11, s47
    v_cmp_ne_u32 vcc, 0, v10
    s_nop 1
    v_cndmask_b32 v11, v11, 8, vcc
    v_xor_b32 v11, v11, v1
    s_movk_i32 s49, 1284
    v_mad_u32_u24 v224, v1, s49, v9
    v_add_u32 v224, 118784, v224
    v_mul_u32_u24 v11, s49, v11
    v_add_u32 v11, 118784, v11
    v_sub_u32 v10, 848, v9
    v_add_u32 v225, v11, v10
    s_lshl_b32 s49, s51, 8
    v_lshl_add_u32 v226, v2, 4, s49
    s_mul_i32 s51, s51, 768
    s_add_u32 s51, s51, 12288
    v_lshl_add_u32 v230, v1, 4, s51
    v_lshl_add_u32 v231, v1, 3, s51
    v_mov_b32 v12, 0x3f803f80
    v_cmp_eq_u32 vcc, 1, v1
    s_nop 1
    v_cndmask_b32 v12, 0, v12, vcc
    s_cmp_lt_u32 s34, 2
    s_cbranch_scc1 L_tprep
    ds_read_u16_d16_hi v112, v224 offset:0
    ds_read_u16_d16_hi v128, v225 offset:432
    v_mov_b32 v144, v12
    ds_read_u16_d16_hi v113, v224 offset:16
    ds_read_u16_d16_hi v129, v225 offset:416
    v_mov_b32 v145, v12
    ds_read_u16_d16_hi v114, v224 offset:32
    ds_read_u16_d16_hi v130, v225 offset:400
    v_mov_b32 v146, v12
    ds_read_u16_d16_hi v115, v224 offset:48
    ds_read_u16_d16_hi v131, v225 offset:384
    v_mov_b32 v147, v12
    ds_read_u16_d16_hi v116, v224 offset:128
    ds_read_u16_d16_hi v132, v225 offset:304
    v_mov_b32 v148, v12
    ds_read_u16_d16_hi v117, v224 offset:144
    ds_read_u16_d16_hi v133, v225 offset:288
    v_mov_b32 v149, v12
    ds_read_u16_d16_hi v118, v224 offset:160
    ds_read_u16_d16_hi v134, v225 offset:272
    v_mov_b32 v150, v12
    ds_read_u16_d16_hi v119, v224 offset:176
    ds_read_u16_d16_hi v135, v225 offset:256
    v_mov_b32 v151, v12
    ds_read_u16_d16_hi v120, v224 offset:256
    ds_read_u16_d16_hi v136, v225 offset:176
    v_mov_b32 v152, v12
    ds_read_u16_d16_hi v121, v224 offset:272
    ds_read_u16_d16_hi v137, v225 offset:160
    v_mov_b32 v153, v12
    ds_read_u16_d16_hi v122, v224 offset:288
    ds_read_u16_d16_hi v138, v225 offset:144
    v_mov_b32 v154, v12
    ds_read_u16_d16_hi v123, v224 offset:304
    ds_read_u16_d16_hi v139, v225 offset:128
    v_mov_b32 v155, v12
    ds_read_u16_d16_hi v124, v224 offset:384
    ds_read_u16_d16_hi v140, v225 offset:48
    v_mov_b32 v156, v12
    ds_read_u16_d16_hi v125, v224 offset:400
    ds_read_u16_d16_hi v141, v225 offset:32
    v_mov_b32 v157, v12
    ds_read_u16_d16_hi v126, v224 offset:416
    ds_read_u16_d16_hi v142, v225 offset:16
    v_mov_b32 v158, v12
    ds_read_u16_d16_hi v127, v224 offset:432
    ds_read_u16_d16_hi v143, v225 offset:0
    v_mov_b32 v159, v12
    s_waitcnt lgkmcnt(0)
    v_pk_add_f32 v[128:129], v[128:129], v[112:113] neg_lo:[0,1] neg_hi:[0,1]
    v_pk_add_f32 v[130:131], v[130:131], v[114:115] neg_lo:[0,1] neg_hi:[0,1]
    v_pk_add_f32 v[132:133], v[132:133], v[116:117] neg_lo:[0,1] neg_hi:[0,1]
    v_pk_add_f32 v[134:135], v[134:135], v[118:119] neg_lo:[0,1] neg_hi:[0,1]
    v_pk_add_f32 v[136:137], v[136:137], v[120:121] neg_lo:[0,1] neg_hi:[0,1]
    v_pk_add_f32 v[138:139], v[138:139], v[122:123] neg_lo:[0,1] neg_hi:[0,1]
    v_pk_add_f32 v[140:141], v[140:141], v[124:125] neg_lo:[0,1] neg_hi:[0,1]
    v_pk_add_f32 v[142:143], v[142:143], v[126:127] neg_lo:[0,1] neg_hi:[0,1]
    s_setprio 1
    s_barrier
    s_mov_b32 s50, 0
    buffer_load_dwordx4 v[16:19], v5, s[8:11], s58 offen sc1
    buffer_load_dwordx4 v[20:23], v7, s[8:11], s58 offen sc1
    buffer_load_dwordx4 v[24:27], v5, s[8:11], s59 offen sc1
    buffer_load_dwordx4 v[28:31], v7, s[8:11], s59 offen sc1
    v_add_u32 v9, 114688, v8
    ds_read_b128 v[80:83], v9 offset:0
    ds_read_b128 v[84:87], v9 offset:1024
    ds_read_b128 v[88:91], v9 offset:2048
    ds_read_b128 v[92:95], v9 offset:3072
    s_mov_b32 exec_lo, 0x10001
    s_mov_b32 exec_hi, 0x10001
    ds_read_b128 v[144:147], v226 offset:20480
    ds_read_b128 v[148:151], v226 offset:20544
    ds_read_b128 v[152:155], v226 offset:20608
    ds_read_b128 v[156:159], v226 offset:20672
    s_mov_b64 exec, -1
    buffer_load_dwordx4 v[32:35], v5, s[8:11], s60 offen sc1
    buffer_load_dwordx4 v[36:39], v7, s[8:11], s60 offen sc1
    buffer_load_dwordx4 v[40:43], v5, s[8:11], s61 offen sc1
    buffer_load_dwordx4 v[44:47], v7, s[8:11], s61 offen sc1
    buffer_load_dwordx4 v[48:51], v5, s[8:11], s62 offen sc1
    buffer_load_dwordx4 v[52:55], v7, s[8:11], s62 offen sc1
    buffer_load_dwordx4 v[56:59], v5, s[8:11], s63 offen sc1
    buffer_load_dwordx4 v[60:63], v7, s[8:11], s63 offen sc1
    buffer_load_dwordx4 v[64:67], v5, s[8:11], s64 offen sc1
    buffer_load_dwordx4 v[68:71], v7, s[8:11], s64 offen sc1
    buffer_load_dwordx4 v[72:75], v5, s[8:11], s65 offen sc1
    buffer_load_dwordx4 v[76:79], v7, s[8:11], s65 offen sc1
    s_waitcnt lgkmcnt(0)
L_zgo:
    v_mov_b32 v10, 0
    s_waitcnt vmcnt(12)
    v_xor_b32 v176, v236, v16
    v_xor_b32 v177, v236, v20
    v_xor_b32 v178, v236, v24
    v_xor_b32 v179, v236, v28
    v_xor_b32 v180, v237, v17
    v_xor_b32 v181, v237, v21
    v_xor_b32 v182, v237, v25
    v_xor_b32 v183, v237, v29
    v_mfma_f32_16x16x32_f16 v[96:99], v[176:179], v[80:83], v[112:115]
    v_or3_b32 v10, v10, v176, v177
    v_or3_b32 v10, v10, v178, v179
    v_xor_b32 v184, v238, v18
    v_xor_b32 v185, v238, v22
    v_xor_b32 v186, v238, v26
    v_xor_b32 v187, v238, v30
    v_mfma_f32_16x16x32_f16 v[100:103], v[180:183], v[80:83], v[116:119]
    v_or3_b32 v10, v10, v180, v181
    v_or3_b32 v10, v10, v182, v183
    v_xor_b32 v188, v239, v19
    v_xor_b32 v189, v239, v23
    v_xor_b32 v190, v239, v27
    v_xor_b32 v191, v239, v31
    v_mfma_f32_16x16x32_f16 v[104:107], v[184:187], v[80:83], v[120:123]
    v_or3_b32 v10, v10, v184, v185
    v_or3_b32 v10, v10, v186, v187
    v_mfma_f32_16x16x32_f16 v[108:111], v[188:191], v[80:83], v[124:127]
    v_or3_b32 v10, v10, v188, v189
    v_or3_b32 v10, v10, v190, v191
    s_waitcnt vmcnt(8)
    v_xor_b32 v192, v236, v32
    v_xor_b32 v193, v236, v36
    v_xor_b32 v194, v236, v40
    v_xor_b32 v195, v236, v44
    v_xor_b32 v196, v237, v33
    v_xor_b32 v197, v237, v37
    v_xor_b32 v198, v237, v41
    v_xor_b32 v199, v237, v45
    v_mfma_f32_16x16x32_f16 v[96:99], v[192:195], v[84:87], v[96:99]
    v_or3_b32 v10, v10, v192, v193
    v_or3_b32 v10, v10, v194, v195
    v_xor_b32 v200, v238, v34
    v_xor_b32 v201, v238, v38
    v_xor_b32 v202, v238, v42
    v_xor_b32 v203, v238, v46
    v_mfma_f32_16x16x32_f16 v[100:103], v[196:199], v[84:87], v[100:103]
    v_or3_b32 v10, v10, v196, v197
    v_or3_b32 v10, v10, v198, v199
    v_xor_b32 v204, v239, v35
    v_xor_b32 v205, v239, v39
    v_xor_b32 v206, v239, v43
    v_xor_b32 v207, v239, v47
    v_mfma_f32_16x16x32_f16 v[104:107], v[200:203], v[84:87], v[104:107]
    v_or3_b32 v10, v10, v200, v201
    v_or3_b32 v10, v10, v202, v203
    v_mfma_f32_16x16x32_f16 v[108:111], v[204:207], v[84:87], v[108:111]
    v_or3_b32 v10, v10, v204, v205
    v_or3_b32 v10, v10, v206, v207
    s_waitcnt vmcnt(4)
    v_xor_b32 v176, v236, v48
    v_xor_b32 v177, v236, v52
    v_xor_b32 v178, v236, v56
    v_xor_b32 v179, v236, v60
    v_xor_b32 v180, v237, v49
    v_xor_b32 v181, v237, v53
    v_xor_b32 v182, v237, v57
    v_xor_b32 v183, v237, v61
    v_mfma_f32_16x16x32_f16 v[96:99], v[176:179], v[88:91], v[96:99]
    v_or3_b32 v10, v10, v176, v177
    v_or3_b32 v10, v10, v178, v179
    v_xor_b32 v184, v238, v50
    v_xor_b32 v185, v238, v54
    v_xor_b32 v186, v238, v58
    v_xor_b32 v187, v238, v62
    v_mfma_f32_16x16x32_f16 v[100:103], v[180:183], v[88:91], v[100:103]
    v_or3_b32 v10, v10, v180, v181
    v_or3_b32 v10, v10, v182, v183
    v_xor_b32 v188, v239, v51
    v_xor_b32 v189, v239, v55
    v_xor_b32 v190, v239, v59
    v_xor_b32 v191, v239, v63
    v_mfma_f32_16x16x32_f16 v[104:107], v[184:187], v[88:91], v[104:107]
    v_or3_b32 v10, v10, v184, v185
    v_or3_b32 v10, v10, v186, v187
    v_mfma_f32_16x16x32_f16 v[108:111], v[188:191], v[88:91], v[108:111]
    v_or3_b32 v10, v10, v188, v189
    v_or3_b32 v10, v10, v190, v191
    s_waitcnt vmcnt(0)
    v_xor_b32 v192, v236, v64
    v_xor_b32 v193, v236, v68
    v_xor_b32 v194, v236, v72
    v_xor_b32 v195, v236, v76
    v_xor_b32 v196, v237, v65
    v_xor_b32 v197, v237, v69
    v_xor_b32 v198, v237, v73
    v_xor_b32 v199, v237, v77
    v_mfma_f32_16x16x32_f16 v[96:99], v[192:195], v[92:95], v[96:99]
    v_xor_b32 v200, v238, v66
    v_xor_b32 v201, v238, v70
    v_xor_b32 v202, v238, v74
    v_xor_b32 v203, v238, v78
    v_mfma_f32_16x16x32_f16 v[100:103], v[196:199], v[92:95], v[100:103]
    v_xor_b32 v204, v239, v67
    v_xor_b32 v205, v239, v71
    v_xor_b32 v206, v239, v75
    v_xor_b32 v207, v239, v79
    v_mfma_f32_16x16x32_f16 v[104:107], v[200:203], v[92:95], v[104:107]
    s_nop 0
    v_mfma_f32_16x16x32_f16 v[108:111], v[204:207], v[92:95], v[108:111]
    v_or3_b32 v10, v10, v192, v193
    v_or3_b32 v10, v10, v194, v195
    v_or3_b32 v10, v10, v196, v197
    v_or3_b32 v10, v10, v198, v199
    v_or3_b32 v10, v10, v200, v201
    v_or3_b32 v10, v10, v202, v203
    v_or3_b32 v10, v10, v204, v205
    v_or3_b32 v10, v10, v206, v207
    v_and_b32 v10, 0x10001, v10
    v_cmp_ne_u32 vcc, 0, v10
    s_nop 0
    s_cbranch_vccnz L_zok_r
L_zok:
    v_cvt_pk_bf16_f32 v160, v96, v97
    v_cvt_pk_bf16_f32 v161, v98, v99
    v_cvt_pk_bf16_f32 v162, v100, v101
    v_cvt_pk_bf16_f32 v163, v102, v103
    v_pk_add_f32 v[96:97], v[96:97], v[128:129]
    v_pk_add_f32 v[98:99], v[98:99], v[130:131]
    v_pk_add_f32 v[100:101], v[100:101], v[132:133]
    v_pk_add_f32 v[102:103], v[102:103], v[134:135]
    v_mfma_f32_16x16x32_bf16 v[208:211], v[160:163], v[160:163], 0
    v_mfma_f32_16x16x32_bf16 v[212:215], v[144:147], v[160:163], 0
    v_cvt_pk_bf16_f32 v168, v96, v97
    v_cvt_pk_bf16_f32 v169, v98, v99
    v_cvt_pk_bf16_f32 v170, v100, v101
    v_cvt_pk_bf16_f32 v171, v102, v103
    v_cvt_pk_bf16_f32 v164, v104, v105
    v_cvt_pk_bf16_f32 v165, v106, v107
    v_cvt_pk_bf16_f32 v166, v108, v109
    v_cvt_pk_bf16_f32 v167, v110, v111
    v_pk_add_f32 v[104:105], v[104:105], v[136:137]
    v_pk_add_f32 v[106:107], v[106:107], v[138:139]
    v_pk_add_f32 v[108:109], v[108:109], v[140:141]
    v_pk_add_f32 v[110:111], v[110:111], v[142:143]
    v_mfma_f32_16x16x32_bf16 v[208:211], v[164:167], v[164:167], v[208:211]
    v_mfma_f32_16x16x32_bf16 v[212:215], v[148:151], v[164:167], v[212:215]
    v_cvt_pk_bf16_f32 v172, v104, v105
    v_cvt_pk_bf16_f32 v173, v106, v107
    v_cvt_pk_bf16_f32 v174, v108, v109
    v_cvt_pk_bf16_f32 v175, v110, v111
    v_mfma_f32_16x16x32_bf16 v[216:219], v[168:171], v[168:171], 0
    v_mfma_f32_16x16x32_bf16 v[220:223], v[152:155], v[168:171], 0
    v_mfma_f32_16x16x32_bf16 v[216:219], v[172:175], v[172:175], v[216:219]
    v_mfma_f32_16x16x32_bf16 v[220:223], v[156:159], v[172:175], v[220:223]
    s_mov_b32 exec_lo, 0x00f0000f
    s_mov_b32 exec_hi, 0xf0000f00
    ds_write_b128 v230, v[208:211]
    s_nop 3
    ds_write_b128 v230, v[216:219] offset:384
    s_mov_b64 exec, 0xffff
    ds_write_b64 v231, v[212:213] offset:256
    ds_write_b64 v231, v[220:221] offset:640
    s_mov_b64 exec, -1
    s_waitcnt lgkmcnt(0)
    s_barrier
    ds_write_b16 v224, v160 offset:0
    ds_write_b16 v225, v168 offset:432
    ds_write_b16_d16_hi v224, v160 offset:16
    ds_write_b16_d16_hi v225, v168 offset:416
    ds_write_b16 v224, v161 offset:32
    ds_write_b16 v225, v169 offset:400
    ds_write_b16_d16_hi v224, v161 offset:48
    ds_write_b16_d16_hi v225, v169 offset:384
    ds_write_b16 v224, v162 offset:128
    ds_write_b16 v225, v170 offset:304
    ds_write_b16_d16_hi v224, v162 offset:144
    ds_write_b16_d16_hi v225, v170 offset:288
    ds_write_b16 v224, v163 offset:160
    ds_write_b16 v225, v171 offset:272
    ds_write_b16_d16_hi v224, v163 offset:176
    ds_write_b16_d16_hi v225, v171 offset:256
    ds_write_b16 v224, v164 offset:256
    ds_write_b16 v225, v172 offset:176
    ds_write_b16_d16_hi v224, v164 offset:272
    ds_write_b16_d16_hi v225, v172 offset:160
    ds_write_b16 v224, v165 offset:288
    ds_write_b16 v225, v173 offset:144
    ds_write_b16_d16_hi v224, v165 offset:304
    ds_write_b16_d16_hi v225, v173 offset:128
    ds_write_b16 v224, v166 offset:384
    ds_write_b16 v225, v174 offset:48
    ds_write_b16_d16_hi v224, v166 offset:400
    ds_write_b16_d16_hi v225, v174 offset:32
    ds_write_b16 v224, v167 offset:416
    ds_write_b16 v225, v175 offset:16
    ds_write_b16_d16_hi v224, v167 offset:432
    ds_write_b16_d16_hi v225, v175 offset:0
L_out:
    s_setprio 0
    s_waitcnt lgkmcnt(0)
    s_barrier
    ds_read2st64_b32 v[40:41], v233 offset0:0 offset1:1
    ds_read2st64_b32 v[42:43], v233 offset0:2 offset1:3
    ds_read_b32 v44, v233 offset:1024
    ds_read_b64 v[52:53], v234 offset:512
    v_add_u32 v232, 10272, v233
    ds_read2st64_b32 v[46:47], v232 offset0:0 offset1:1
    ds_read2st64_b32 v[48:49], v232 offset0:2 offset1:3
    ds_read_b32 v50, v232 offset:1024
    ds_read_b64 v[54:55], v234 offset:576
    s_waitcnt lgkmcnt(4)
    v_lshlrev_b32 v16, 16, v40
    v_and_b32 v17, 0xffff0000, v40
    v_lshlrev_b32 v18, 16, v41
    v_and_b32 v19, 0xffff0000, v41
    v_lshlrev_b32 v20, 16, v42
    v_and_b32 v21, 0xffff0000, v42
    v_lshlrev_b32 v22, 16, v43
    v_and_b32 v23, 0xffff0000, v43
    v_lshlrev_b32 v24, 16, v44
    v_and_b32 v25, 0xffff0000, v44
    v_pk_fma_f32 v[16:17], v[16:17], v[52:53], v[52:53] op_sel:[0,0,1] op_sel_hi:[1,0,1] neg_lo:[0,0,1] neg_hi:[0,0,1]
    v_pk_fma_f32 v[18:19], v[18:19], v[52:53], v[52:53] op_sel:[0,0,1] op_sel_hi:[1,0,1] neg_lo:[0,0,1] neg_hi:[0,0,1]
    v_pk_fma_f32 v[20:21], v[20:21], v[52:53], v[52:53] op_sel:[0,0,1] op_sel_hi:[1,0,1] neg_lo:[0,0,1] neg_hi:[0,0,1]
    v_pk_fma_f32 v[22:23], v[22:23], v[52:53], v[52:53] op_sel:[0,0,1] op_sel_hi:[1,0,1] neg_lo:[0,0,1] neg_hi:[0,0,1]
    v_pk_fma_f32 v[24:25], v[24:25], v[52:53], v[52:53] op_sel:[0,0,1] op_sel_hi:[1,0,1] neg_lo:[0,0,1] neg_hi:[0,0,1]
    v_cvt_pk_bf16_f32 v56, v16, v17
    v_min_u32 v56, -2, v56
    buffer_store_dword v56, v6, s[12:15], s56 offen offset:0 sc1
    v_cvt_pk_bf16_f32 v57, v18, v19
    v_min_u32 v57, -2, v57
    buffer_store_dword v57, v6, s[12:15], s56 offen offset:256 sc1
    v_cvt_pk_bf16_f32 v58, v20, v21
    v_min_u32 v58, -2, v58
    buffer_store_dword v58, v6, s[12:15], s56 offen offset:512 sc1
    v_cvt_pk_bf16_f32 v59, v22, v23
    v_min_u32 v59, -2, v59
    buffer_store_dword v59, v6, s[12:15], s56 offen offset:768 sc1
    v_cvt_pk_bf16_f32 v60, v24, v25
    v_min_u32 v60, -2, v60
    buffer_store_dword v60, v6, s[12:15], s56 offen offset:1024 sc1
    s_waitcnt lgkmcnt(0)
    v_lshlrev_b32 v26, 16, v46
    v_and_b32 v27, 0xffff0000, v46
    v_lshlrev_b32 v28, 16, v47
    v_and_b32 v29, 0xffff0000, v47
    v_lshlrev_b32 v30, 16, v48
    v_and_b32 v31, 0xffff0000, v48
    v_lshlrev_b32 v32, 16, v49
    v_and_b32 v33, 0xffff0000, v49
    v_lshlrev_b32 v34, 16, v50
    v_and_b32 v35, 0xffff0000, v50
    v_pk_fma_f32 v[26:27], v[26:27], v[54:55], v[54:55] op_sel:[0,0,1] op_sel_hi:[1,0,1] neg_lo:[0,0,1] neg_hi:[0,0,1]
    v_pk_fma_f32 v[28:29], v[28:29], v[54:55], v[54:55] op_sel:[0,0,1] op_sel_hi:[1,0,1] neg_lo:[0,0,1] neg_hi:[0,0,1]
    v_pk_fma_f32 v[30:31], v[30:31], v[54:55], v[54:55] op_sel:[0,0,1] op_sel_hi:[1,0,1] neg_lo:[0,0,1] neg_hi:[0,0,1]
    v_pk_fma_f32 v[32:33], v[32:33], v[54:55], v[54:55] op_sel:[0,0,1] op_sel_hi:[1,0,1] neg_lo:[0,0,1] neg_hi:[0,0,1]
    v_pk_fma_f32 v[34:35], v[34:35], v[54:55], v[54:55] op_sel:[0,0,1] op_sel_hi:[1,0,1] neg_lo:[0,0,1] neg_hi:[0,0,1]
    v_cvt_pk_bf16_f32 v64, v26, v27
    v_min_u32 v64, -2, v64
    buffer_store_dword v64, v6, s[12:15], s57 offen offset:0 sc1
    v_cvt_pk_bf16_f32 v65, v28, v29
    v_min_u32 v65, -2, v65
    buffer_store_dword v65, v6, s[12:15], s57 offen offset:256 sc1
    v_cvt_pk_bf16_f32 v66, v30, v31
    v_min_u32 v66, -2, v66
    buffer_store_dword v66, v6, s[12:15], s57 offen offset:512 sc1
    v_cvt_pk_bf16_f32 v67, v32, v33
    v_min_u32 v67, -2, v67
    buffer_store_dword v67, v6, s[12:15], s57 offen offset:768 sc1
    v_cvt_pk_bf16_f32 v68, v34, v35
    v_min_u32 v68, -2, v68
    buffer_store_dword v68, v6, s[12:15], s57 offen offset:1024 sc1
    s_cmp_lg_u32 s34, 3
    s_cbranch_scc1 L_finp
    s_cmp_lg_u32 s2, 0
    s_cbranch_scc1 L_finp
    s_mov_b64 exec, 1
    buffer_store_dword v14, v5, s[8:11], 0 offen sc1
L_finp:
    s_endpgm
L_pub0:
    s_cmp_eq_u32 s34, 2
    s_cbranch_scc1 L_idle
    s_barrier
    s_mul_i32 s40, s34, s39
    s_add_u32 s40, s40, s38
    s_sub_u32 s41, 2048, s40
    s_cmp_eq_u32 s40, 0
    s_cselect_b32 s41, 1024, s41
    s_mul_i32 s56, s40, 1280
    s_mul_i32 s57, s41, 1280
    s_mul_i32 s49, s34, 1284
    s_add_u32 s49, s49, 118784
    v_add_u32 v233, s49, v6
    v_lshlrev_b32 v234, 3, v3
    s_cmp_eq_u32 s38, 0
    s_cselect_b32 s47, 0, 8
    v_add_u32 v9, 139520, v8
    v_add_u32 v10, 140544, v6
    ds_read_b128 v[16:19], v9
    ds_read_b32 v20, v10
    v_lshrrev_b32 v22, 2, v4
    v_and_b32 v23, 7, v22
    v_mov_b32 v11, s47
    v_cmp_ne_u32 vcc, 0, v23
    s_nop 1
    v_cndmask_b32 v11, v11, 8, vcc
    v_and_b32 v24, 1, v4
    v_mul_u32_u24 v11, v11, v24
    v_xor_b32 v11, v11, v22
    v_and_b32 v24, 3, v4
    v_mul_u32_u24 v24, 384, v24
    v_lshl_add_u32 v26, v11, 3, v24
    v_lshl_add_u32 v25, v11, 4, v24
    v_and_b32 v11, 3, v11
    v_lshl_add_u32 v25, v11, 2, v25
    v_mul_u32_u24 v23, s39, v23
    v_add_u32 v23, s38, v23
    v_sub_u32 v9, 2048, v23
    v_mov_b32 v10, 1024
    v_cmp_eq_u32 vcc, 0, v23
    s_nop 1
    v_cndmask_b32 v9, v9, v10, vcc
    v_cmp_lt_u32 vcc, 31, v4
    s_nop 1
    v_cndmask_b32 v23, v23, v9, vcc
    v_lshlrev_b32 v23, 6, v23
    v_lshlrev_b32 v27, 3, v22
    v_mov_b32 v46, v14
    v_mov_b32 v47, v14
    s_mul_i32 s54, s35, 64
    s_add_u32 s54, s54, 32768
    buffer_load_dword v253, v5, s[8:11], s54 offen
    s_lshr_b32 s36, s2, 6
    s_lshl2_add_u32 s36, s36, s33
    s_lshl_b32 s43, s37, 8
    s_lshl2_add_u32 s36, s36, s43
    s_add_u32 s36, s36, 4096
    s_mov_b32 s47, 0xffff8000
    s_mov_b32 s50, 0x11111111
    s_mov_b32 s51, s50
    s_brev_b32 s52, 1
    s_mov_b32 s48, 2752512
    s_mov_b32 s49, 0x3f803f80
    v_mov_b32 v21, 0
    s_waitcnt lgkmcnt(0)
    v_dot2c_f32_bf16 v21, s49, v16
    v_dot2c_f32_bf16 v21, s49, v17
    v_dot2c_f32_bf16 v21, s49, v18
    v_dot2c_f32_bf16 v21, s49, v19
    v_dot2c_f32_bf16 v21, s49, v20
    s_nop 2
    v_add_f32_dpp v21, v21, v21 row_shr:1 row_mask:0xf bank_mask:0xf bound_ctrl:0
    s_nop 1
    v_add_f32_dpp v21, v21, v21 row_shr:2 row_mask:0xf bank_mask:0xf bound_ctrl:0
    s_nop 1
    v_add_f32_dpp v21, v21, v21 row_shr:4 row_mask:0xf bank_mask:0xf bound_ctrl:0
    s_nop 1
    v_add_f32_dpp v21, v21, v21 row_shr:8 row_mask:0xf bank_mask:0xf bound_ctrl:0
    s_nop 1
    v_add_f32_dpp v21, v21, v21 row_bcast:15 row_mask:0xa bank_mask:0xf
    s_nop 1
    v_add_f32_dpp v21, v21, v21 row_bcast:31 row_mask:0xc bank_mask:0xf
    s_nop 0
    v_readlane_b32 s55, v21, 63
    s_setprio 3
    s_barrier
    ds_read_b32 v36, v25 offset:12288
    ds_read_b64 v[30:31], v26 offset:12544
    ds_read_b32 v37, v25 offset:13824
    ds_read_b64 v[32:33], v26 offset:14080
    ds_read_b32 v38, v25 offset:15360
    ds_read_b64 v[34:35], v26 offset:15616
    s_waitcnt lgkmcnt(2)
    v_add_f32 v36, v36, v37
    v_pk_add_f32 v[30:31], v[30:31], v[32:33]
    s_waitcnt lgkmcnt(0)
    v_add_f32 v36, v36, v38
    v_add_f32 v40, v31, v35
    v_add_f32 v41, v30, v34
    v_add_f32_dpp v36, v36, v36 quad_perm:[1,0,3,2] row_mask:0xf bank_mask:0xf
    v_add_f32_dpp v40, v40, v40 quad_perm:[1,0,3,2] row_mask:0xf bank_mask:0xf
    v_add_f32_dpp v41, v41, v41 quad_perm:[1,0,3,2] row_mask:0xf bank_mask:0xf
    v_add_f32_dpp v36, v36, v36 quad_perm:[2,3,0,1] row_mask:0xf bank_mask:0xf
    v_add_f32_dpp v40, v40, v40 quad_perm:[2,3,0,1] row_mask:0xf bank_mask:0xf
    v_add_f32_dpp v41, v41, v41 quad_perm:[2,3,0,1] row_mask:0xf bank_mask:0xf
    v_mul_f32 v44, s45, v40
    v_mul_f32 v48, v44, v44
    v_fma_f32 v36, v36, s45, -v48
    v_max_f32 v36, 0, v36
    v_cvt_pk_bf16_f32 v36, 0, v36
    v_add_f32 v36, 0x3727c5ac, v36
    v_cvt_pk_bf16_f32 v36, 0, v36
    v_sqrt_f32 v36, v36
    v_cvt_pk_bf16_f32 v44, 0, v44
    v_cvt_pk_bf16_f32 v36, 0, v36
    v_rcp_f32 v50, v36
    v_fma_f32 v41, -v44, s55, v41
    v_mul_f32 v41, v41, v50
    v_cvt_pk_bf16_f32 v41, v41, v41
    v_ashrrev_i32 v48, 31, v41
    s_mov_b64 exec, s[50:51]
    v_bitop3_b32 v41, v41, v48, s52 bitop3:0x1e
    v_lshrrev_b32 v41, 1, v41
    v_bfi_b32 v41, s47, v41, v14
    buffer_store_dword v41, v4, s[8:11], s54 offen sc1
    buffer_store_dword v14, v5, s[8:11], s36 offen
    v_add_f32 v45, 1.0, v36
    v_mul_f32 v51, v44, v50
    v_add_f32 v50, 1.0, v50
    v_rcp_f32 v45, v45
    ds_write_b64 v27, v[50:51] offset:512
    buffer_store_dwordx4 v[44:47], v23, s[8:11], s48 offen sc1
    s_mov_b64 exec, -1
    s_setprio 0
    s_branch L_out
.p2align 12
L_ffn:
    s_barrier
    s_cmp_lg_u32 s34, 0
    s_cbranch_scc1 L_noflag
    s_mul_i32 s49, s35, 64
    s_add_u32 s49, s49, 2883584
    s_mov_b64 exec, 1
    buffer_store_dword v14, v13, s[8:11], s49 offen sc1
    s_mov_b64 exec, -1
L_noflag:
    s_cmp_ge_u32 s35, 108
    s_cbranch_scc1 L_setup
    v_lshrrev_b32 v13, 1, v4
    v_and_b32 v9, 2, v13
    v_bfe_u32 v10, v13, 3, 1
    v_and_b32 v13, 21, v13
    v_lshl_or_b32 v13, v9, 2, v13
    v_lshl_or_b32 v13, v10, 1, v13
    v_mul_u32_u24 v13, 3456, v13
    v_and_b32 v9, 1, v4
    v_lshl_add_u32 v13, v9, 4, v13
    s_lshl_b32 s58, s35, 5
    s_and_b32 s47, s33, 3
    s_mul_i32 s47, s47, 5
    s_add_u32 s48, s34, 5
L_dma1:
    s_add_u32 s49, s48, s47
    s_cmp_ge_u32 s49, 20
    s_cselect_b32 s50, 20, 0
    s_sub_u32 s49, s49, s50
    s_lshr_b32 s50, s49, 2
    s_lshl_b32 s50, s50, 13
    s_and_b32 s51, s49, 3
    s_lshl_b32 s51, s51, 10
    s_add_u32 s50, s50, s51
    s_add_u32 m0, s50, 114688
    s_mul_i32 s51, s49, 110592
    s_add_u32 s51, s51, s58
    buffer_load_dwordx4 v13, s[20:23], s51 offen lds
    s_add_u32 m0, m0, 4096
    s_add_u32 s48, s48, 8
    buffer_load_dwordx4 v13, s[24:27], s51 offen lds
    s_cmp_lt_u32 s48, 20
    s_cbranch_scc1 L_dma1
L_setup:
    v_lshrrev_b32 v7, 2, v0
    v_mul_u32_u24 v7, 64, v7
    v_and_b32 v12, 3, v0
    v_lshl_add_u32 v7, v12, 4, v7
    s_mov_b32 s52, 32768
    v_and_b32 v9, 1, v1
    v_mul_u32_u24 v144, 0xaaaa, v9
    v_or_b32 v144, 0x4444, v144
    v_bfe_u32 v9, v0, 4, 3
    v_lshlrev_b32 v9, 1, v9
    v_add_u32 v40, 1, v9
    v_sub_u32 v41, 32, v9
    v_sub_u32 v42, 32, v40
    v_cmp_eq_u32 vcc, 0, v9
    s_nop 1
    v_cndmask_b32 v41, v41, 16, vcc
    v_and_b32 v12, 128, v0
    v_cmp_ne_u32 vcc, 0, v12
    s_nop 1
    v_cndmask_b32 v9, v9, v41, vcc
    v_cndmask_b32 v40, v40, v42, vcc
    v_bfe_u32 v10, v0, 2, 2
    v_and_b32 v12, 1, v0
    v_lshl_add_u32 v10, v10, 1, v12
    v_lshlrev_b32 v10, 2, v10
    v_mov_b32 v11, 64
    v_cmp_eq_u32 vcc, 0, v9
    s_nop 1
    v_cndmask_b32 v11, v11, 32, vcc
    v_mad_u32_u24 v24, v10, v11, v9
    v_lshl_add_u32 v28, v10, 6, v40
    v_add_u32 v25, v24, v11
    v_add_u32 v29, 64, v28
    v_add_u32 v26, v25, v11
    v_add_u32 v30, 64, v29
    v_add_u32 v27, v26, v11
    v_add_u32 v31, 64, v30
    v_and_b32 v12, 2, v0
    v_cmp_ne_u32 vcc, 0, v12
    v_sub_u32 v9, 2048, v24
    s_nop 0
    v_cndmask_b32 v24, v24, v9, vcc
    v_sub_u32 v9, 2048, v25
    v_cndmask_b32 v25, v25, v9, vcc
    v_sub_u32 v9, 2048, v26
    v_cndmask_b32 v26, v26, v9, vcc
    v_sub_u32 v9, 2048, v27
    v_cndmask_b32 v27, v27, v9, vcc
    v_sub_u32 v9, 2048, v28
    v_cndmask_b32 v28, v28, v9, vcc
    v_sub_u32 v9, 2048, v29
    v_cndmask_b32 v29, v29, v9, vcc
    v_sub_u32 v9, 2048, v30
    v_cndmask_b32 v30, v30, v9, vcc
    v_sub_u32 v9, 2048, v31
    v_cndmask_b32 v31, v31, v9, vcc
    v_mov_b32 v11, 1024
    v_cmp_eq_u32 vcc, 2, v0
    s_nop 1
    v_cndmask_b32 v24, v24, v11, vcc
    s_mov_b32 s53, 36864
    s_lshr_b32 s54, s2, 6
    s_and_b32 s43, s33, 3
    s_lshl2_add_u32 s54, s54, s43
    s_mov_b32 s55, 16777216
    s_cmp_eq_u32 s54, 10
    s_cmov_b32 s55, 2752512
    s_cmp_lt_u32 s54, 10
    s_cselect_b32 s54, s54, 131072
    s_lshl_b32 s54, s54, 7
    v_mov_b32 v12, 0
    v_lshrrev_b32 v5, 4, v0
    v_lshlrev_b32 v5, 2, v5
    v_lshlrev_b32 v151, 2, v1
    v_lshlrev_b32 v43, 4, v2
    v_lshrrev_b32 v147, 1, v1
    v_lshrrev_b32 v9, 3, v4
    s_cmp_ge_u32 s34, 5
    s_cselect_b64 vcc, -1, 0
    v_cndmask_b32 v147, v147, v9, vcc
    v_lshlrev_b32 v147, 2, v147
    v_and_b32 v148, 1, v1
    v_lshl_add_u32 v148, v2, 1, v148
    v_lshlrev_b32 v148, 4, v148
    s_cmp_lt_u32 s35, 108
    s_cselect_b32 s43, 7, 8
    v_lshlrev_b32 v149, s43, v2
    v_lshl_add_u32 v149, v1, 2, v149
    v_lshl_add_u32 v149, v3, 10, v149
    v_add_u32 v149, 2048, v149
    s_lshl_b32 s56, s34, 8
    s_movk_i32 s57, 1280
    v_mov_b32 v152, 1
    v_mov_b32 v153, 0x7fff
    v_mov_b32 v158, 0
    v_mov_b32 v156, 0
    s_mov_b32 s52, 32768
    s_mov_b32 s59, 0x7fff8000
    s_cmp_ge_u32 s35, 108
    s_cbranch_scc1 L_f2load
    v_lshrrev_b32 v9, 1, v2
    v_and_b32 v10, 1, v2
    v_lshlrev_b32 v15, 3, v1
    v_lshl_add_u32 v15, v10, 7, v15
    v_lshl_add_u32 v15, v9, 9, v15
    v_add_u32 v15, 114688, v15
    s_waitcnt vmcnt(0)
    s_barrier
    s_branch L_tk
L_f2load:
    s_waitcnt vmcnt(0)
    s_barrier
    v_bfe_u32 v13, v4, 2, 1
    v_and_b32 v9, 8, v4
    v_or_b32 v13, v13, v9
    v_lshl_or_b32 v13, v2, 1, v13
    v_mul_u32_u24 v13, 1280, v13
    v_and_b32 v9, 2, v2
    v_xor_b32 v9, v9, v4
    v_and_b32 v9, 3, v9
    v_lshl_add_u32 v13, v9, 4, v13
    s_sub_u32 s58, s35, 108
    s_lshl_b32 s58, s58, 6
    s_and_b32 s47, s33, 1
    s_mov_b32 s47, 0
    s_mov_b32 s48, s34
L_dma2:
    s_add_u32 s49, s48, s47
    s_cmp_ge_u32 s49, 112
    s_cselect_b32 s50, 112, 0
    s_sub_u32 s49, s49, s50
    s_lshl_b32 s50, s49, 10
    s_add_u32 m0, s50, 12288
    s_mul_i32 s51, s49, 20480
    s_add_u32 s51, s51, s58
    s_add_u32 s48, s48, 8
    buffer_load_dwordx4 v13, s[28:31], s51 offen lds
    s_cmp_lt_u32 s48, 112
    s_cbranch_scc1 L_dma2
    v_lshrrev_b32 v9, 2, v1
    v_and_b32 v10, 3, v1
    v_lshlrev_b32 v15, 9, v2
    v_lshl_add_u32 v15, v9, 6, v15
    v_lshl_add_u32 v15, v10, 3, v15
    v_and_b32 v9, 1, v2
    v_lshl_add_u32 v15, v9, 5, v15
    v_lshl_add_u32 v15, v3, 14, v15
    v_xor_b32 v145, 32, v15
    s_cmp_lg_u32 s34, 0
    s_cbranch_scc1 L_dok
    v_mul_u32_u24 v11, 64, v4
    s_mov_b32 s49, 2883584
    s_mov_b32 s47, 2887680
    s_mov_b32 s50, 0
L_dpoll:
    buffer_load_dword v9, v11, s[8:11], s49 offen sc1
    buffer_load_dword v10, v11, s[8:11], s47 offen sc1
    s_waitcnt vmcnt(0)
    v_bitop3_b32 v9, v9, v10, v14 bitop3:0x7e
    v_cmp_ne_u32 vcc, 0, v9
    s_nop 0
    s_cbranch_vccnz L_dok_r
L_dok:
    s_waitcnt vmcnt(0)
    s_barrier
    s_cmp_eq_u32 s34, 7
    s_cbranch_scc1 L_f2fin
    ds_read_b64_tr_b16 v[48:49], v15 offset:12288
    ds_read_b64_tr_b16 v[50:51], v15 offset:12544
    ds_read_b64_tr_b16 v[52:53], v15 offset:14336
    ds_read_b64_tr_b16 v[54:55], v15 offset:14592
    ds_read_b64_tr_b16 v[56:57], v145 offset:12288
    ds_read_b64_tr_b16 v[58:59], v145 offset:12544
    ds_read_b64_tr_b16 v[60:61], v145 offset:14336
    ds_read_b64_tr_b16 v[62:63], v145 offset:14592
    ds_read_b64_tr_b16 v[64:65], v15 offset:16384
    ds_read_b64_tr_b16 v[66:67], v15 offset:16640
    ds_read_b64_tr_b16 v[68:69], v15 offset:18432
    ds_read_b64_tr_b16 v[70:71], v15 offset:18688
    ds_read_b64_tr_b16 v[72:73], v145 offset:16384
    ds_read_b64_tr_b16 v[74:75], v145 offset:16640
    ds_read_b64_tr_b16 v[76:77], v145 offset:18432
    ds_read_b64_tr_b16 v[78:79], v145 offset:18688
    ds_read_b64_tr_b16 v[80:81], v15 offset:20480
    ds_read_b64_tr_b16 v[82:83], v15 offset:20736
    ds_read_b64_tr_b16 v[84:85], v15 offset:22528
    ds_read_b64_tr_b16 v[86:87], v15 offset:22784
    ds_read_b64_tr_b16 v[88:89], v145 offset:20480
    ds_read_b64_tr_b16 v[90:91], v145 offset:20736
    ds_read_b64_tr_b16 v[92:93], v145 offset:22528
    ds_read_b64_tr_b16 v[94:95], v145 offset:22784
    ds_read_b64_tr_b16 v[96:97], v15 offset:24576
    ds_read_b64_tr_b16 v[98:99], v15 offset:24832
    ds_read_b64_tr_b16 v[100:101], v15 offset:26624
    ds_read_b64_tr_b16 v[102:103], v15 offset:26880
    ds_read_b64_tr_b16 v[104:105], v145 offset:24576
    ds_read_b64_tr_b16 v[106:107], v145 offset:24832
    ds_read_b64_tr_b16 v[108:109], v145 offset:26624
    ds_read_b64_tr_b16 v[110:111], v145 offset:26880
    s_branch L_f2
L_tk:
    s_cmp_eq_u32 s34, 6
    s_cbranch_scc1 L_pad0
    s_cmp_eq_u32 s34, 7
    s_cbranch_scc1 L_fchk
    s_cmp_lg_u32 s34, 4
    s_cbranch_scc1 L_tk1
    s_branch L_w4prep
L_tk1:
    s_barrier
    s_cmp_ge_u32 s34, 4
    s_cbranch_scc1 L_tk2
    s_mov_b32 s50, 0
L_kpoll:
    buffer_load_dwordx4 v[16:19], v7, s[8:11], s52 offen sc1
    buffer_load_dwordx4 v[20:23], v7, s[8:11], s53 offen sc1
    s_waitcnt vmcnt(1)
    v_max3_u32 v10, v16, v17, v18
    v_bitop3_b32 v40, v16, v17, v14 bitop3:0x7e
    v_bitop3_b32 v41, v18, v19, v14 bitop3:0x7e
    s_waitcnt vmcnt(0)
    v_max3_u32 v11, v19, v20, v21
    v_max3_u32 v10, v10, v22, v23
    v_max_u32 v10, v10, v11
    v_bitop3_b32 v42, v20, v21, v14 bitop3:0x7e
    v_bitop3_b32 v11, v22, v23, v14 bitop3:0x7e
    v_max_u32_dpp v10, v10, v10 row_ror:1 row_mask:0xf bank_mask:0xf
    v_or3_b32 v40, v40, v41, v42
    v_bitop3_b32 v40, v40, v11, v153 bitop3:0xa8
    v_max_u32_dpp v10, v10, v10 row_ror:2 row_mask:0xf bank_mask:0xf
    v_cmp_ne_u32 vcc, 0, v40
    v_and_or_b32 v16, v16, s59, v24
    v_max_u32_dpp v10, v10, v10 row_ror:4 row_mask:0xf bank_mask:0xf
    s_cbranch_vccnz L_kok_r
L_kok:
    v_and_or_b32 v17, v17, s59, v25
    v_max_u32_dpp v10, v10, v10 row_ror:8 row_mask:0xf bank_mask:0xf
    v_and_or_b32 v10, v10, s59, v5
    ds_write_b32 v5, v10 offset:128
    v_and_or_b32 v18, v18, s59, v26
    v_and_or_b32 v19, v19, s59, v27
    v_and_or_b32 v20, v20, s59, v28
    v_and_or_b32 v21, v21, s59, v29
    v_and_or_b32 v22, v22, s59, v30
    v_and_or_b32 v23, v23, s59, v31
    v_max3_u32 v9, v16, v17, v18
    v_max3_u32 v11, v19, v20, v21
    v_max3_u32 v9, v9, v22, v23
    v_max_u32 v9, v9, v11
L_tk2:
    s_waitcnt lgkmcnt(0)
    s_barrier
    s_cmp_ge_u32 s34, 4
    s_cbranch_scc1 L_tk3
    ds_read_b32 v10, v151 offset:128
    ds_read_b128 v[112:115], v43 offset:128
    v_and_b32 v159, 2047, v9
    v_lshlrev_b32 v160, 6, v159
    v_mul_u32_u24 v159, 1280, v159
    s_waitcnt lgkmcnt(0)
    v_sub_u32 v112, v10, v112
    v_sub_u32 v113, v10, v113
    v_sub_u32 v114, v10, v114
    v_sub_u32 v115, v10, v115
    v_lshrrev_b32 v11, 31, v112
    v_alignbit_b32 v11, v11, v113, 31
    v_alignbit_b32 v11, v11, v114, 31
    v_alignbit_b32 v11, v11, v115, 31
    v_bcnt_u32_b32 v11, v11, 0
    v_mov_b32 v112, v11
    s_nop 1
    v_permlane16_swap_b32 v11, v112
    v_add_u32 v11, v11, v112
    v_mov_b32 v112, v11
    s_nop 1
    v_permlane32_swap_b32 v11, v112
    v_add_u32 v11, v11, v112
    v_cmp_eq_u32 vcc, 7, v11
    s_nop 0
    s_ff1_i32_b64 s47, vcc
    v_readlane_b32 s48, v10, s47
    s_nop 0
    s_and_b32 s48, s48, s59
    v_cmp_le_i32 vcc, s48, v9
    v_mov_b32 v10, v9
    s_cbranch_vccz L_tk3
    s_mov_b64 exec, vcc
    ds_add_rtn_u32 v11, v12, v152
    buffer_load_dword v253, v159, s[12:15], s54 offen sc1
    buffer_load_dword v253, v160, s[8:11], s55 offen sc1
    s_branch L_app2
L_tkagain:
    v_mov_b32 v10, v9
L_app:
    v_cmp_le_i32 vcc, s48, v10
    s_nop 0
    s_cbranch_vccz L_tk3
    s_mov_b64 exec, vcc
    ds_add_rtn_u32 v11, v12, v152
    v_and_b32 v32, 2047, v10
    v_lshlrev_b32 v33, 6, v32
    v_mul_u32_u24 v32, 1280, v32
    buffer_load_dword v253, v33, s[8:11], s55 offen sc1
    buffer_load_dword v253, v32, s[12:15], s54 offen sc1
L_app2:
    s_mov_b64 exec, -1
    v_add_u32 v40, -1, v10
    v_sub_u32 v32, v40, v16
    v_sub_u32 v33, v40, v17
    v_sub_u32 v34, v40, v18
    v_sub_u32 v35, v40, v19
    v_sub_u32 v36, v40, v20
    v_sub_u32 v37, v40, v21
    v_sub_u32 v38, v40, v22
    v_sub_u32 v39, v40, v23
    v_min3_u32 v32, v32, v33, v34
    v_min3_u32 v35, v35, v36, v37
    v_min3_u32 v32, v32, v38, v39
    v_min3_u32 v32, v32, v35, v10
    s_waitcnt lgkmcnt(0)
    v_min_u32 v11, 16, v11
    v_lshlrev_b32 v11, 2, v11
    s_mov_b64 exec, vcc
    ds_write_b32 v11, v10 offset:192
    v_sub_u32 v10, v40, v32
    s_mov_b64 exec, -1
    s_branch L_app
L_dok_r:
    s_add_u32 s50, s50, 1
    s_cmp_gt_u32 s50, 65536
    s_cbranch_scc1 L_dok
    s_branch L_dpoll
L_kok_r:
    s_add_u32 s50, s50, 1
    s_cmp_gt_u32 s50, 65536
    s_cbranch_scc1 L_kok
    s_branch L_kpoll
L_pad0:
    s_branch L_pad1
L_fchk:
    s_lshl_b32 s49, s37, 8
    s_add_u32 s49, s49, 4096
    s_mov_b32 s50, 0
    s_mov_b64 exec, 0xffff
L_h1:
    buffer_load_dword v10, v6, s[8:11], s49 offen sc1
    s_add_u32 s50, s50, 1
    s_cmp_gt_u32 s50, 64
    s_waitcnt vmcnt(0)
    v_cmp_ne_u32 vcc, v14, v10
    s_cbranch_scc1 L_h1_d
    s_cbranch_vccnz L_h1
L_h1_d:
    s_mov_b64 exec, -1
    s_branch L_tk1
L_tk3:
    s_waitcnt lgkmcnt(0)
    s_barrier
    ds_read_b32 v41, v12
    ds_read_b32 v10, v151 offset:192
    ds_read_b128 v[112:115], v43 offset:192
    s_waitcnt lgkmcnt(0)
    v_sub_u32 v112, v10, v112
    v_sub_u32 v113, v10, v113
    v_sub_u32 v114, v10, v114
    v_sub_u32 v115, v10, v115
    v_lshrrev_b32 v11, 31, v112
    v_alignbit_b32 v11, v11, v113, 31
    v_alignbit_b32 v11, v11, v114, 31
    v_alignbit_b32 v11, v11, v115, 31
    v_bcnt_u32_b32 v11, v11, 0
    v_mov_b32 v112, v11
    s_nop 1
    v_permlane16_swap_b32 v11, v112
    v_add_u32 v11, v11, v112
    v_mov_b32 v112, v11
    s_nop 1
    v_permlane32_swap_b32 v11, v112
    v_add_u32 v11, v11, v112
    v_cmp_gt_u32 vcc, 8, v11
    v_readfirstlane_b32 s47, v41
    v_lshlrev_b32 v11, 2, v11
    s_mov_b64 exec, vcc
    ds_write_b32 v11, v10 offset:32
    s_mov_b64 exec, -1
    ds_read_b32 v150, v147 offset:32
    ds_read_b64 v[154:155], v158 offset:32
    s_mov_b32 s50, 0
    s_cmp_le_u32 s47, 16
    s_cbranch_scc1 L_tkdone
    ds_read_b32 v10, v12 offset:60
    s_waitcnt lgkmcnt(0)
    s_barrier
    v_readfirstlane_b32 s48, v10
    v_mov_b32 v11, -1
    ds_write_b32 v12, v12
    ds_write_b32 v151, v11 offset:192
    s_waitcnt lgkmcnt(0)
    s_barrier
    s_cmp_ge_u32 s34, 4
    s_cbranch_scc1 L_tk3
    s_branch L_tkagain
L_pad1:
    s_branch L_pad2
L_tkdone:
    s_cmp_lg_u32 s34, 4
    s_cbranch_scc1 L_selpub
    s_waitcnt lgkmcnt(0)
    v_and_b32 v9, 2047, v150
    v_mad_u32_u24 v9, v9, s57, v148
    v_and_b32 v154, 2047, v154
    v_and_b32 v155, 2047, v155
    v_lshlrev_b32 v154, 6, v154
    v_lshlrev_b32 v155, 6, v155
L_gretry:
    buffer_load_dwordx4 v[16:19], v9, s[12:15], 0 offen offset:0 sc1
    buffer_load_dwordx4 v[20:23], v9, s[12:15], 0 offen offset:128 sc1
    buffer_load_dwordx4 v[24:27], v9, s[12:15], 0 offen offset:256 sc1
    buffer_load_dwordx4 v[28:31], v9, s[12:15], 0 offen offset:384 sc1
    buffer_load_dwordx4 v[32:35], v9, s[12:15], 0 offen offset:512 sc1
    buffer_load_dwordx4 v[36:39], v9, s[12:15], 0 offen offset:640 sc1
    buffer_load_dwordx4 v[112:115], v9, s[12:15], 0 offen offset:768 sc1
    buffer_load_dwordx4 v[116:119], v9, s[12:15], 0 offen offset:896 sc1
    buffer_load_dwordx4 v[120:123], v9, s[12:15], 0 offen offset:1024 sc1
    buffer_load_dwordx4 v[124:127], v9, s[12:15], 0 offen offset:1152 sc1
    buffer_load_dwordx3 v[136:138], v154, s[8:11], s60 offen sc1
    buffer_load_dwordx3 v[140:142], v155, s[8:11], s60 offen sc1
    v_mov_b32 v128, 0
    v_mov_b32 v129, 0
    v_mov_b32 v130, 0
    v_mov_b32 v131, 0
    v_mov_b32 v132, 0
    v_mov_b32 v133, 0
    v_mov_b32 v134, 0
    v_mov_b32 v135, 0
    v_mov_b32 v10, 0
    s_waitcnt vmcnt(11)
    v_smfmac_f32_16x16x64_bf16 v[128:131], v[16:19], v[48:55], v144
    v_max3_u32 v10, v10, v16, v17
    v_smfmac_f32_16x16x64_bf16 v[132:135], v[16:19], v[160:167], v144
    v_max3_u32 v10, v10, v18, v19
    s_waitcnt vmcnt(10)
    v_smfmac_f32_16x16x64_bf16 v[128:131], v[20:23], v[56:63], v144
    v_max3_u32 v10, v10, v20, v21
    v_smfmac_f32_16x16x64_bf16 v[132:135], v[20:23], v[168:175], v144
    v_max3_u32 v10, v10, v22, v23
    s_waitcnt vmcnt(9)
    v_smfmac_f32_16x16x64_bf16 v[128:131], v[24:27], v[64:71], v144
    v_max3_u32 v10, v10, v24, v25
    v_smfmac_f32_16x16x64_bf16 v[132:135], v[24:27], v[176:183], v144
    v_max3_u32 v10, v10, v26, v27
    s_waitcnt vmcnt(8)
    v_smfmac_f32_16x16x64_bf16 v[128:131], v[28:31], v[72:79], v144
    v_max3_u32 v10, v10, v28, v29
    v_smfmac_f32_16x16x64_bf16 v[132:135], v[28:31], v[184:191], v144
    v_max3_u32 v10, v10, v30, v31
    s_waitcnt vmcnt(7)
    v_smfmac_f32_16x16x64_bf16 v[128:131], v[32:35], v[80:87], v144
    v_max3_u32 v10, v10, v32, v33
    v_smfmac_f32_16x16x64_bf16 v[132:135], v[32:35], v[192:199], v144
    v_max3_u32 v10, v10, v34, v35
    s_waitcnt vmcnt(6)
    v_smfmac_f32_16x16x64_bf16 v[128:131], v[36:39], v[88:95], v144
    v_max3_u32 v10, v10, v36, v37
    v_smfmac_f32_16x16x64_bf16 v[132:135], v[36:39], v[200:207], v144
    v_max3_u32 v10, v10, v38, v39
    s_waitcnt vmcnt(5)
    v_smfmac_f32_16x16x64_bf16 v[128:131], v[112:115], v[96:103], v144
    v_max3_u32 v10, v10, v112, v113
    v_smfmac_f32_16x16x64_bf16 v[132:135], v[112:115], v[208:215], v144
    v_max3_u32 v10, v10, v114, v115
    s_waitcnt vmcnt(4)
    v_smfmac_f32_16x16x64_bf16 v[128:131], v[116:119], v[104:111], v144
    v_max3_u32 v10, v10, v116, v117
    v_smfmac_f32_16x16x64_bf16 v[132:135], v[116:119], v[216:223], v144
    v_max3_u32 v10, v10, v118, v119
    s_waitcnt vmcnt(3)
    v_smfmac_f32_16x16x64_bf16 v[128:131], v[120:123], v[240:247], v144
    v_max3_u32 v10, v10, v120, v121
    v_smfmac_f32_16x16x64_bf16 v[132:135], v[120:123], v[224:231], v144
    v_max3_u32 v10, v10, v122, v123
    s_waitcnt vmcnt(2)
    v_smfmac_f32_16x16x64_bf16 v[128:131], v[124:127], v[248:255], v144
    v_max3_u32 v10, v10, v124, v125
    v_smfmac_f32_16x16x64_bf16 v[132:135], v[124:127], v[232:239], v144
    v_max3_u32 v10, v10, v126, v127
    v_cmp_eq_u32 s[62:63], -1, v10
    s_waitcnt vmcnt(0)
    v_bitop3_b32 v10, v138, v142, v14 bitop3:0x7e
    v_mul_f32 v44, 0xbfb8aa3b, v137
    v_cmp_ne_u32 vcc, 0, v10
    v_mul_f32 v45, 0xbfb8aa3b, v141
    v_mul_f32 v137, v137, v137
    s_or_b64 vcc, vcc, s[62:63]
    v_mul_f32 v141, v141, v141
    s_cbranch_vccnz L_gok_r
L_gok:
    v_fma_f32 v128, -v136, v46, v128
    v_fma_f32 v130, -v140, v46, v130
    v_add_f32 v128, v128, v129
    v_add_f32 v130, v130, v131
    v_mul_f32 v44, v44, v128
    v_mul_f32 v45, v45, v130
    v_exp_f32 v44, v44
    v_exp_f32 v45, v45
    v_fma_f32 v132, -v136, v47, v132
    v_fma_f32 v134, -v140, v47, v134
    v_add_f32 v44, 1.0, v44
    v_add_f32 v45, 1.0, v45
    v_rcp_f32 v44, v44
    v_rcp_f32 v45, v45
    v_add_f32 v132, v132, v133
    v_add_f32 v134, v134, v135
    v_mul_f32 v128, v128, v137
    v_mul_f32 v130, v130, v141
    v_mul_f32 v128, v128, v44
    v_mul_f32 v130, v130, v45
    v_mul_f32 v128, v128, v132
    v_mul_f32 v130, v130, v134
    v_cvt_pk_bf16_f32 v44, v128, v130
    s_nop 1
    v_mov_b32_dpp v45, v44 quad_perm:[1,0,3,2] row_mask:0xf bank_mask:0xf
    v_perm_b32 v44, v45, v44, v157
    v_min_u32 v44, -2, v44
    buffer_store_dword v14, v12, s[8:11], s64 offen
    buffer_store_dword v44, v156, s[8:11], s61 offen sc1
    s_mov_b64 exec, 1
    s_endpgm
L_gok_r:
    s_add_u32 s50, s50, 1
    s_cmp_gt_u32 s50, 65536
    s_cbranch_scc1 L_gok
    s_branch L_gretry
L_selpub:
    s_cmp_lg_u32 s34, 5
    s_cbranch_scc1 L_fin2
    s_cmp_lg_u32 s54, 0
    s_cbranch_scc1 L_fin2
    ds_read_b32 v150, v6 offset:32
    v_mov_b32 v151, v14
    v_lshlrev_b32 v9, 3, v4
    s_lshl_b32 s49, s37, 8
    s_add_u32 s49, s49, 12288
    s_mov_b64 exec, 0xffff
    s_waitcnt lgkmcnt(0)
    buffer_store_dwordx2 v[150:151], v9, s[8:11], s49 offen sc1
    s_branch L_fin2
L_pad2:
    s_branch L_tk1
L_f2:
    s_lshl_b32 s51, s34, 12
    s_add_u32 s51, s51, 98304
    v_mov_b32 v124, 0
    v_mov_b32 v125, 0
    v_mov_b32 v126, 0
    v_mov_b32 v127, 0
    s_lshl_b32 s49, s37, 8
    s_add_u32 s49, s49, 8192
    s_mov_b32 s50, 0
    s_mov_b64 exec, 0xfff
L_h2:
    buffer_load_dword v10, v6, s[8:11], s49 offen sc1
    s_add_u32 s50, s50, 1
    s_cmp_gt_u32 s50, 64
    s_waitcnt vmcnt(0)
    v_cmp_ne_u32 vcc, v14, v10
    s_cbranch_scc1 L_h2_d
    s_cbranch_vccnz L_h2
L_h2_d:
    s_mov_b64 exec, -1
    s_mov_b32 s50, 0
    s_waitcnt lgkmcnt(0)
L_a2:
    buffer_load_dwordx4 v[112:115], v8, s[8:11], s51 offen offset:0 sc1
    buffer_load_dwordx4 v[116:119], v8, s[8:11], s51 offen offset:1024 sc1
    buffer_load_dwordx4 v[120:123], v8, s[8:11], s51 offen offset:2048 sc1
    s_cmp_eq_u32 s34, 6
    s_cbranch_scc1 L_a3
    buffer_load_dwordx4 v[124:127], v8, s[8:11], s51 offen offset:3072 sc1
L_a3:
    v_mov_b32 v10, 0
    v_mov_b32 v128, 0
    v_mov_b32 v129, 0
    v_mov_b32 v130, 0
    v_mov_b32 v131, 0
    v_mov_b32 v132, 0
    v_mov_b32 v133, 0
    v_mov_b32 v134, 0
    v_mov_b32 v135, 0
    s_waitcnt vmcnt(2)
    v_smfmac_f32_16x16x64_bf16 v[128:131], v[112:115], v[48:55], v144
    v_max3_u32 v10, v10, v112, v113
    v_smfmac_f32_16x16x64_bf16 v[132:135], v[112:115], v[56:63], v144
    v_max3_u32 v10, v10, v114, v115
    s_waitcnt vmcnt(1)
    v_smfmac_f32_16x16x64_bf16 v[128:131], v[116:119], v[64:71], v144
    v_max3_u32 v10, v10, v116, v117
    v_smfmac_f32_16x16x64_bf16 v[132:135], v[116:119], v[72:79], v144
    v_max3_u32 v10, v10, v118, v119
    s_waitcnt vmcnt(0)
    v_smfmac_f32_16x16x64_bf16 v[128:131], v[120:123], v[80:87], v144
    v_max3_u32 v10, v10, v120, v121
    v_smfmac_f32_16x16x64_bf16 v[132:135], v[120:123], v[88:95], v144
    v_max3_u32 v10, v10, v122, v123
    v_smfmac_f32_16x16x64_bf16 v[128:131], v[124:127], v[96:103], v144
    v_max3_u32 v10, v10, v124, v125
    v_smfmac_f32_16x16x64_bf16 v[132:135], v[124:127], v[104:111], v144
    v_max3_u32 v10, v10, v126, v127
    v_cmp_eq_u32 vcc, -1, v10
    s_nop 0
    s_cbranch_vccnz L_a4_r
L_a4:
    s_nop 1
    v_add_f32 v128, v128, v129
    v_add_f32 v130, v130, v131
    ds_write2_b32 v149, v128, v130 offset0:0 offset1:32
    v_add_f32 v132, v132, v133
    v_add_f32 v134, v134, v135
    ds_write2_b32 v149, v132, v134 offset0:16 offset1:48
    s_waitcnt lgkmcnt(0)
    s_barrier
    s_endpgm
L_a4_r:
    s_add_u32 s50, s50, 1
    s_cmp_gt_u32 s50, 65536
    s_cbranch_scc1 L_a4
    s_branch L_a2
L_f2fin:
    v_and_b32 v13, 7, v4
    v_and_b32 v9, 56, v4
    s_lshl_b32 s49, s37, 8
    s_add_u32 s49, s49, 12288
    s_mov_b32 s50, 0
L_spoll:
    buffer_load_dwordx2 v[150:151], v9, s[8:11], s49 offen sc1
    s_waitcnt vmcnt(0)
    v_cmp_ne_u32 vcc, v14, v151
    s_nop 0
    s_cbranch_vccnz L_spok_r
L_spok:
    v_and_b32 v46, 2047, v150
    v_mul_u32_u24 v46, 1280, v46
    v_lshl_add_u32 v46, v13, 3, v46
L_oretry:
    buffer_load_dwordx2 v[44:45], v46, s[12:15], s58 offen sc1
    s_waitcnt vmcnt(0)
    v_max_u32 v10, v44, v45
    v_cmp_eq_u32 vcc, -1, v10
    s_nop 0
    s_cbranch_vccnz L_ook_r
L_ook:
    v_lshlrev_b32 v9, 1, v150
    v_ashrrev_i32 v10, 31, v9
    v_not_b32 v10, v10
    v_or_b32 v10, 0x80000000, v10
    v_xor_b32 v9, v9, v10
    v_and_b32 v9, 0xffff0000, v9
    v_mul_f32 v9, 0xbfb8aa3b, v9
    v_exp_f32 v9, v9
    s_nop 0
    v_add_f32 v9, 1.0, v9
    v_rcp_f32 v47, v9
    v_lshlrev_b32 v48, 16, v44
    v_and_b32 v49, 0xffff0000, v44
    v_lshlrev_b32 v50, 16, v45
    v_and_b32 v51, 0xffff0000, v45
    s_barrier
    ds_read_b128 v[16:19], v8 offset:2048
    ds_read_b128 v[20:23], v8 offset:3072
    ds_read_b128 v[24:27], v8 offset:4096
    ds_read_b128 v[28:31], v8 offset:5120
    ds_read_b128 v[32:35], v8 offset:6144
    ds_read_b128 v[36:39], v8 offset:7168
    ds_read_b128 v[40:43], v8 offset:8192
    s_waitcnt lgkmcnt(5)
    v_pk_add_f32 v[16:17], v[16:17], v[20:21]
    v_pk_add_f32 v[18:19], v[18:19], v[22:23]
    s_waitcnt lgkmcnt(3)
    v_pk_add_f32 v[24:25], v[24:25], v[28:29]
    v_pk_add_f32 v[26:27], v[26:27], v[30:31]
    s_waitcnt lgkmcnt(1)
    v_pk_add_f32 v[32:33], v[32:33], v[36:37]
    v_pk_add_f32 v[34:35], v[34:35], v[38:39]
    v_pk_add_f32 v[16:17], v[16:17], v[24:25]
    v_pk_add_f32 v[18:19], v[18:19], v[26:27]
    s_waitcnt lgkmcnt(0)
    v_pk_add_f32 v[32:33], v[32:33], v[40:41]
    v_pk_add_f32 v[34:35], v[34:35], v[42:43]
    v_pk_add_f32 v[16:17], v[16:17], v[32:33]
    v_pk_add_f32 v[18:19], v[18:19], v[34:35]
    v_fma_f32 v48, v16, v47, v48
    v_fma_f32 v49, v17, v47, v49
    v_fma_f32 v50, v18, v47, v50
    v_fma_f32 v51, v19, v47, v51
    v_cvt_pk_bf16_f32 v44, v48, v49
    v_cvt_pk_bf16_f32 v45, v50, v51
    buffer_store_dwordx2 v[44:45], v46, s[12:15], s58 offen
L_fin:
L_fin2:
L_end:
    s_endpgm
L_spok_r:
    s_add_u32 s50, s50, 1
    s_cmp_gt_u32 s50, 65536
    s_cbranch_scc1 L_spok
    s_branch L_spoll
L_ook_r:
    s_add_u32 s50, s50, 1
    s_cmp_gt_u32 s50, 65536
    s_cbranch_scc1 L_ook
    s_branch L_oretry
.p2align 12
L_idle:
    s_mov_b32 s49, 139520
    v_add_u32 v9, s33, v2
    v_and_b32 v9, 3, v9
    v_bfe_u32 v10, v4, 1, 1
    v_lshl_add_u32 v9, v9, 1, v10
    v_add_u32 v9, -1, v9
    v_and_b32 v9, 7, v9
    v_and_b32 v10, 1, v4
    v_lshl_add_u32 v9, v10, 5, v9
    v_and_b32 v10, 4, v4
    v_lshl_add_u32 v9, v10, 5, v9
    v_lshlrev_b32 v9, 1, v9
    v_add_u32 v16, 139522, v9
    v_sub_u32 v17, 140798, v9
    v_mov_b32 v18, 16
    v_and_b32 v10, 8, v4
    v_cmp_ne_u32 vcc, 0, v10
    s_nop 1
    v_cndmask_b32 v16, v16, v17, vcc
    v_cndmask_b32 v18, v18, -16, vcc
    v_lshrrev_b32 v9, 4, v4
    v_and_b32 v10, 3, v4
    v_lshl_add_u32 v9, v9, 2, v10
    v_add_u32 v9, -1, v9
    v_and_b32 v9, 7, v9
    v_lshlrev_b32 v9, 1, v9
    v_add_u32 v19, 140034, v9
    v_sub_u32 v17, 140286, v9
    v_cndmask_b32 v19, v19, v17, vcc
    v_mad_i32_i24 v20, v18, 0, v16
    ds_read_u16 v24, v20
    v_mad_i32_i24 v20, v18, 1, v16
    ds_read_u16 v25, v20
    v_mad_i32_i24 v20, v18, 2, v16
    ds_read_u16 v26, v20
    v_mad_i32_i24 v20, v18, 3, v16
    ds_read_u16 v27, v20
    v_mad_i32_i24 v20, v18, 8, v16
    ds_read_u16 v28, v20
    v_mad_i32_i24 v20, v18, 9, v16
    ds_read_u16 v29, v20
    v_mad_i32_i24 v20, v18, 10, v16
    ds_read_u16 v30, v20
    v_mad_i32_i24 v20, v18, 11, v16
    ds_read_u16 v31, v20
    v_mad_i32_i24 v20, v18, 0, v19
    ds_read_u16 v32, v20
    v_mad_i32_i24 v20, v18, 4, v19
    ds_read_u16 v33, v20
    v_mad_i32_i24 v20, v18, 1, v19
    ds_read_u16 v34, v20
    v_mad_i32_i24 v20, v18, 5, v19
    ds_read_u16 v35, v20
    v_mad_i32_i24 v20, v18, 2, v19
    ds_read_u16 v36, v20
    v_mad_i32_i24 v20, v18, 6, v19
    ds_read_u16 v37, v20
    v_mad_i32_i24 v20, v18, 3, v19
    ds_read_u16 v38, v20
    v_mad_i32_i24 v20, v18, 7, v19
    v_writelane_b32 v20, s49, 8
    ds_read_u16 v39, v20
    s_waitcnt lgkmcnt(0)
    v_lshl_or_b32 v40, v25, 16, v24
    v_lshl_or_b32 v41, v27, 16, v26
    v_lshl_or_b32 v42, v29, 16, v28
    v_lshl_or_b32 v43, v31, 16, v30
    v_lshl_or_b32 v44, v33, 16, v32
    v_lshl_or_b32 v45, v35, 16, v34
    v_lshl_or_b32 v46, v37, 16, v36
    v_lshl_or_b32 v47, v39, 16, v38
    ds_write_b128 v8, v[40:43] offset:20992
    s_mov_b32 exec_hi, 0
    ds_write_b128 v8, v[44:47] offset:20480
    s_mov_b64 exec, -1
    s_waitcnt lgkmcnt(0)
    s_barrier
    s_mul_i32 s40, s34, s39
    s_add_u32 s40, s40, s38
    s_sub_u32 s41, 2048, s40
    s_cmp_eq_u32 s40, 0
    s_cselect_b32 s41, 1024, s41
    s_mul_i32 s56, s40, 1280
    s_mul_i32 s57, s41, 1280
    s_mul_i32 s49, s34, 1284
    s_add_u32 s49, s49, 118784
    v_add_u32 v233, s49, v6
    v_lshlrev_b32 v234, 3, v3
    s_cmp_eq_u32 s38, 0
    s_cselect_b32 s47, 0, 8
    s_barrier
    s_branch L_out
L_w4prep:
    ds_read_b64_tr_b16 v[48:49], v15 offset:0
    ds_read_b64_tr_b16 v[50:51], v15 offset:256
    ds_read_b64_tr_b16 v[52:53], v15 offset:1024
    ds_read_b64_tr_b16 v[54:55], v15 offset:1280
    ds_read_b64_tr_b16 v[160:161], v15 offset:4096
    ds_read_b64_tr_b16 v[162:163], v15 offset:4352
    ds_read_b64_tr_b16 v[164:165], v15 offset:5120
    ds_read_b64_tr_b16 v[166:167], v15 offset:5376
    ds_read_b64_tr_b16 v[56:57], v15 offset:2048
    ds_read_b64_tr_b16 v[58:59], v15 offset:2304
    ds_read_b64_tr_b16 v[60:61], v15 offset:3072
    ds_read_b64_tr_b16 v[62:63], v15 offset:3328
    ds_read_b64_tr_b16 v[168:169], v15 offset:6144
    ds_read_b64_tr_b16 v[170:171], v15 offset:6400
    ds_read_b64_tr_b16 v[172:173], v15 offset:7168
    ds_read_b64_tr_b16 v[174:175], v15 offset:7424
    ds_read_b64_tr_b16 v[64:65], v15 offset:8192
    ds_read_b64_tr_b16 v[66:67], v15 offset:8448
    ds_read_b64_tr_b16 v[68:69], v15 offset:9216
    ds_read_b64_tr_b16 v[70:71], v15 offset:9472
    ds_read_b64_tr_b16 v[176:177], v15 offset:12288
    ds_read_b64_tr_b16 v[178:179], v15 offset:12544
    ds_read_b64_tr_b16 v[180:181], v15 offset:13312
    ds_read_b64_tr_b16 v[182:183], v15 offset:13568
    ds_read_b64_tr_b16 v[72:73], v15 offset:10240
    ds_read_b64_tr_b16 v[74:75], v15 offset:10496
    ds_read_b64_tr_b16 v[76:77], v15 offset:11264
    ds_read_b64_tr_b16 v[78:79], v15 offset:11520
    ds_read_b64_tr_b16 v[184:185], v15 offset:14336
    ds_read_b64_tr_b16 v[186:187], v15 offset:14592
    ds_read_b64_tr_b16 v[188:189], v15 offset:15360
    ds_read_b64_tr_b16 v[190:191], v15 offset:15616
    ds_read_b64_tr_b16 v[80:81], v15 offset:16384
    ds_read_b64_tr_b16 v[82:83], v15 offset:16640
    ds_read_b64_tr_b16 v[84:85], v15 offset:17408
    ds_read_b64_tr_b16 v[86:87], v15 offset:17664
    ds_read_b64_tr_b16 v[192:193], v15 offset:20480
    ds_read_b64_tr_b16 v[194:195], v15 offset:20736
    ds_read_b64_tr_b16 v[196:197], v15 offset:21504
    ds_read_b64_tr_b16 v[198:199], v15 offset:21760
    ds_read_b64_tr_b16 v[88:89], v15 offset:18432
    ds_read_b64_tr_b16 v[90:91], v15 offset:18688
    ds_read_b64_tr_b16 v[92:93], v15 offset:19456
    ds_read_b64_tr_b16 v[94:95], v15 offset:19712
    ds_read_b64_tr_b16 v[200:201], v15 offset:22528
    ds_read_b64_tr_b16 v[202:203], v15 offset:22784
    ds_read_b64_tr_b16 v[204:205], v15 offset:23552
    ds_read_b64_tr_b16 v[206:207], v15 offset:23808
    ds_read_b64_tr_b16 v[96:97], v15 offset:24576
    ds_read_b64_tr_b16 v[98:99], v15 offset:24832
    ds_read_b64_tr_b16 v[100:101], v15 offset:25600
    ds_read_b64_tr_b16 v[102:103], v15 offset:25856
    ds_read_b64_tr_b16 v[208:209], v15 offset:28672
    ds_read_b64_tr_b16 v[210:211], v15 offset:28928
    ds_read_b64_tr_b16 v[212:213], v15 offset:29696
    ds_read_b64_tr_b16 v[214:215], v15 offset:29952
    ds_read_b64_tr_b16 v[104:105], v15 offset:26624
    ds_read_b64_tr_b16 v[106:107], v15 offset:26880
    ds_read_b64_tr_b16 v[108:109], v15 offset:27648
    ds_read_b64_tr_b16 v[110:111], v15 offset:27904
    ds_read_b64_tr_b16 v[216:217], v15 offset:30720
    ds_read_b64_tr_b16 v[218:219], v15 offset:30976
    ds_read_b64_tr_b16 v[220:221], v15 offset:31744
    ds_read_b64_tr_b16 v[222:223], v15 offset:32000
    ds_read_b64_tr_b16 v[240:241], v15 offset:32768
    ds_read_b64_tr_b16 v[242:243], v15 offset:33024
    ds_read_b64_tr_b16 v[244:245], v15 offset:33792
    ds_read_b64_tr_b16 v[246:247], v15 offset:34048
    ds_read_b64_tr_b16 v[224:225], v15 offset:36864
    ds_read_b64_tr_b16 v[226:227], v15 offset:37120
    ds_read_b64_tr_b16 v[228:229], v15 offset:37888
    ds_read_b64_tr_b16 v[230:231], v15 offset:38144
    s_barrier
    ds_read_b64_tr_b16 v[248:249], v15 offset:34816
    ds_read_b64_tr_b16 v[250:251], v15 offset:35072
    ds_read_b64_tr_b16 v[252:253], v15 offset:35840
    ds_read_b64_tr_b16 v[254:255], v15 offset:36096
    ds_read_b64_tr_b16 v[232:233], v15 offset:38912
    ds_read_b64_tr_b16 v[234:235], v15 offset:39168
    ds_read_b64_tr_b16 v[236:237], v15 offset:39936
    ds_read_b64_tr_b16 v[238:239], v15 offset:40192
    v_mov_b32 v16, 0x3f803f80
    v_mov_b32 v17, 0x3f803f80
    v_mov_b32 v18, 0x3f803f80
    v_mov_b32 v19, 0x3f803f80
    v_mov_b32 v128, 0
    v_mov_b32 v129, 0
    v_mov_b32 v130, 0
    v_mov_b32 v131, 0
    v_mov_b32 v132, 0
    v_mov_b32 v133, 0
    v_mov_b32 v134, 0
    v_mov_b32 v135, 0
    v_lshlrev_b32 v158, 3, v2
    v_and_b32 v9, 1, v1
    v_lshl_add_u32 v156, v2, 1, v9
    v_lshlrev_b32 v156, 5, v156
    v_and_b32 v10, 14, v1
    v_lshl_add_u32 v156, v10, 1, v156
    v_mov_b32 v157, 0x05040100
    v_mov_b32 v10, 0x03020706
    v_cmp_eq_u32 vcc, 1, v9
    s_nop 1
    v_cndmask_b32 v157, v157, v10, vcc
    s_mov_b32 s60, 2752512
    s_lshl_b32 s61, s35, 8
    s_add_u32 s61, s61, 98304
    s_lshr_b32 s64, s2, 6
    s_and_b32 s43, s33, 3
    s_lshl2_add_u32 s64, s64, s43
    s_lshl_b32 s43, s37, 8
    s_lshl2_add_u32 s64, s64, s43
    s_add_u32 s64, s64, 8192
    s_waitcnt lgkmcnt(0)
    v_smfmac_f32_16x16x64_bf16 v[128:131], v[16:19], v[48:55], v144
    v_smfmac_f32_16x16x64_bf16 v[132:135], v[16:19], v[160:167], v144
    v_smfmac_f32_16x16x64_bf16 v[128:131], v[16:19], v[56:63], v144
    v_smfmac_f32_16x16x64_bf16 v[132:135], v[16:19], v[168:175], v144
    v_smfmac_f32_16x16x64_bf16 v[128:131], v[16:19], v[64:71], v144
    v_smfmac_f32_16x16x64_bf16 v[132:135], v[16:19], v[176:183], v144
    v_smfmac_f32_16x16x64_bf16 v[128:131], v[16:19], v[72:79], v144
    v_smfmac_f32_16x16x64_bf16 v[132:135], v[16:19], v[184:191], v144
    v_smfmac_f32_16x16x64_bf16 v[128:131], v[16:19], v[80:87], v144
    v_smfmac_f32_16x16x64_bf16 v[132:135], v[16:19], v[192:199], v144
    v_smfmac_f32_16x16x64_bf16 v[128:131], v[16:19], v[88:95], v144
    v_smfmac_f32_16x16x64_bf16 v[132:135], v[16:19], v[200:207], v144
    v_smfmac_f32_16x16x64_bf16 v[128:131], v[16:19], v[96:103], v144
    v_smfmac_f32_16x16x64_bf16 v[132:135], v[16:19], v[208:215], v144
    v_smfmac_f32_16x16x64_bf16 v[128:131], v[16:19], v[104:111], v144
    v_smfmac_f32_16x16x64_bf16 v[132:135], v[16:19], v[216:223], v144
    v_smfmac_f32_16x16x64_bf16 v[128:131], v[16:19], v[240:247], v144
    v_smfmac_f32_16x16x64_bf16 v[132:135], v[16:19], v[224:231], v144
    v_smfmac_f32_16x16x64_bf16 v[128:131], v[16:19], v[248:255], v144
    v_smfmac_f32_16x16x64_bf16 v[132:135], v[16:19], v[232:239], v144
    s_nop 6
    v_add_f32 v46, v128, v129
    v_add_f32 v47, v132, v133
    s_setprio 2
    s_barrier
    s_branch L_tk3
L_last:
    s_endpgm
.section .rodata,"a"
.p2align 6
.amdhsa_kernel sequential_preLN__spectral_fnet__moe_arch_mod__prompt_kernel
  .amdhsa_next_free_vgpr 256
  .amdhsa_next_free_sgpr 102
  .amdhsa_accum_offset 256
  .amdhsa_group_segment_fixed_size 0
  .amdhsa_kernarg_size 104
  .amdhsa_user_sgpr_count 2
  .amdhsa_user_sgpr_kernarg_segment_ptr 1
  .amdhsa_system_sgpr_workgroup_id_x 1
.end_amdhsa_kernel
```
